```python
import torch

def _softmax(x, axis=-1):
    return torch.softmax(x, dim=axis)
def _gelu(x):
    return torch.nn.functional.gelu(x, approximate="tanh")
def _silu(x):
    return torch.nn.functional.silu(x)
def _sigmoid(x):
    return torch.sigmoid(x)
def _layernorm(x, axis=-1, eps=1e-5):
    m = x.mean(dim=axis, keepdim=True)
    v = x.var(dim=axis, keepdim=True, unbiased=False)
    return (x - m) / torch.sqrt(v + eps)
def _scatter_add(tgt, idx, src, axis=0):
    return tgt.clone().index_add_(axis, idx, src)
def _segment_sum(src, seg, n):
    out = torch.zeros((n,) + src.shape[1:], dtype=src.dtype)
    return out.index_add_(0, seg, src)
def _pad(x, pw):
    flat = tuple(v for pair in reversed(pw) for v in pair)
    return torch.nn.functional.pad(x, flat)

kernel_name = 'interleave_layers__sliding_block_cached__glu_gated_swiglu__decode'

def setup_inputs():

    _w = (lambda a: (lambda t: t.to(torch.bfloat16) if t.is_floating_point() else t)(torch.as_tensor(a)))
    def _A_setup():
        B, Sq, D = 4, 1, 512
        Hq, Hkv, Sk, Dh = 32, 8, 4096, 128
        assert Hq % Hkv == 0, (Hq, Hkv)
        return {
            "x": _w((lambda *s: torch.randn(*s, dtype=torch.bfloat16) * 0.05)(B, Sq, D)),
            "k_cache": _w((lambda *s: torch.randn(*s, dtype=torch.bfloat16) * 0.8)(B, Hkv, Sk, Dh)),
            "v_cache": _w((lambda *s: torch.randn(*s, dtype=torch.bfloat16) * 0.8)(B, Hkv, Sk, Dh)),
            "wq": _w((lambda *s: torch.randn(*s, dtype=torch.bfloat16) * 0.8)(D, Hq * Dh) * (D ** -0.5)),
            "wo": _w((lambda *s: torch.randn(*s, dtype=torch.bfloat16) * 0.8)(Hq * Dh, D) * ((Hq * Dh) ** -0.5)),
        }
    _A_in = _A_setup()

    def _B_setup():
        B, S, D, F = 4, 1, 512, 1792
        return {
            "x": _w((lambda *s: torch.randn(*s, dtype=torch.bfloat16) * 0.05)(B, S, D)),
            "w1": _w((lambda *s: torch.randn(*s, dtype=torch.bfloat16) * 0.2)(D, F) * (2.0 / D) ** 0.5),
            "w3": _w((lambda *s: torch.randn(*s, dtype=torch.bfloat16) * 0.2)(D, F) * (2.0 / D) ** 0.5),
            "w2": _w((lambda *s: torch.randn(*s, dtype=torch.bfloat16) * 0.2)(F, D) * (2.0 / F) ** 0.5),
        }
    _B_in = _B_setup()

    return {
        "A_x": _A_in["x"],
        "A_k_cache": _A_in["k_cache"],
        "A_v_cache": _A_in["v_cache"],
        "A_wq": _A_in["wq"],
        "A_wo": _A_in["wo"],
        "B_x": _B_in["x"],
        "B_w1": _B_in["w1"],
        "B_w3": _B_in["w3"],
        "B_w2": _B_in["w2"],
    }

def reference(A_x, A_k_cache, A_v_cache, A_wq, A_wo, B_x, B_w1, B_w3, B_w2):
    def _A_ref(x, k_cache, v_cache, wq, wo):
        B, Sq, D = x.shape
        Hq, Dh = 32, 128
        Hkv, Sk = k_cache.shape[1], k_cache.shape[2]
        W = min(4096, max(256, Sk // 4))
        rep = Hq // Hkv
        q = (lambda x, *d: x.permute(*d))((x @ wq).reshape(B, Sq, Hq, Dh), 0, 2, 1, 3)
        k = (lambda x, n, axis: torch.repeat_interleave(x, n, dim=axis))(k_cache[:, :, Sk - W:, :], rep, axis=1)
        v = (lambda x, n, axis: torch.repeat_interleave(x, n, dim=axis))(v_cache[:, :, Sk - W:, :], rep, axis=1)
        scores = torch.einsum("bhqd,bhkd->bhqk", q, k) * (Dh ** -0.5)
        p = _softmax(scores, axis=-1)
        o = torch.einsum("bhqk,bhkd->bhqd", p, v)
        return (lambda x, *d: x.permute(*d))(o, 0, 2, 1, 3).reshape(B, Sq, Hq * Dh) @ wo

    def _B_ref(x, w1, w3, w2):
        gate = torch.einsum("bsd,df->bsf", x, w1)
        up = torch.einsum("bsd,df->bsf", x, w3)
        h = _silu(gate) * up
        out = torch.einsum("bsf,fd->bsd", h, w2)
        return out

    x = A_x
    x = x + _A_ref(_layernorm(x, axis=-1), A_k_cache, A_v_cache, A_wq, A_wo)
    x = x + _B_ref(_layernorm(x, axis=-1), B_w1, B_w3, B_w2)
    x = x + _A_ref(_layernorm(x, axis=-1), A_k_cache, A_v_cache, A_wq, A_wo)
    x = x + _B_ref(_layernorm(x, axis=-1), B_w1, B_w3, B_w2)
    return x
```

```asm
; @launch grid=(256,1,1) block=(384,1,1) lds=154624
.amdgcn_target "amdgcn-amd-amdhsa--gfx950"
.text
.globl interleave_layers__sliding_block_cached__glu_gated_swiglu__decode_kernel
.p2align 12
.p2align 8
.type interleave_layers__sliding_block_cached__glu_gated_swiglu__decode_kernel,@function
interleave_layers__sliding_block_cached__glu_gated_swiglu__decode_kernel:
    s_cmp_ge_u32 s2, 256
    s_cbranch_scc1 L_end
    s_load_dwordx16 s[8:23], s[0:1], 0
    s_load_dwordx8 s[24:31], s[0:1], 64
    s_getpc_b64 s[4:5]
L_pc:
    s_mov_b32 s6, L_end-L_pc
    s_mov_b32 s7, 0x00020000
    s_lshr_b32 s46, s2, 3
    s_lshl_b32 s54, s46, 7
    v_lshlrev_b32 v5, 12, v0
    buffer_load_dword v13, v5, s[4:7], s54 offen
    v_lshrrev_b32 v4, 6, v0
    v_and_b32 v1, 63, v0
    v_readfirstlane_b32 s44, v4
    s_and_b32 s45, s2, 7
    s_and_b32 s52, s46, 3
    s_lshr_b32 s53, s46, 2
    v_lshrrev_b32 v2, 4, v1
    v_and_b32 v3, 15, v1
    s_mul_i32 s51, s45, 0x2c000
    s_mov_b32 s35, s7
    s_mov_b32 s34, 0x500000
    s_cmp_eq_u32 s44, 5
    s_cbranch_scc1 L_ld
    v_lshlrev_b32 v8, 4, v1
    v_and_b32 v4, 3, v3
    s_movk_i32 s6, 4096
    s_cmp_eq_u32 s44, 4
    s_cbranch_scc1 L_comm0
    s_and_b32 s55, s46, 1
    s_cselect_b32 s41, s45, s53
    s_lshl1_add_u32 s55, s44, s55
    s_lshl_b32 s55, s55, 2
    s_lshr_b32 s55, 0x98764321, s55
    s_and_b32 s55, s55, 15
    s_lshl_b32 s55, s55, 3
    s_load_dwordx2 s[36:37], s[0:1], s55
    s_lshl_b32 s41, s41, 19
    s_cmp_eq_u32 s44, 1
    s_cselect_b32 s41, s41, 0
    s_and_b32 s55, s46, 24
    s_add_u32 s55, s55, s45
    s_lshl_b32 s55, s55, 20
    s_cmp_eq_u32 s44, 0
    s_cselect_b32 s41, s55, s41
    v_lshl_add_u32 v5, v4, 2, v2
    v_lshlrev_b32 v27, 1, v5
    v_lshrrev_b32 v5, 2, v3
    v_lshl_add_u32 v27, v5, 10, v27
    v_mov_b32 v108, -1
    v_mov_b32 v109, -1
    v_mov_b32 v110, -1
    v_mov_b32 v111, -1
    v_min_u32 v106, 0x370, v8
    s_lshl2_add_u32 s60, s53, s44
    s_lshl_b32 s60, s60, 5
    s_lshl2_add_u32 s61, s46, s44
    s_mulk_i32 s61, 896
    s_add_u32 s54, s61, s51
    s_waitcnt lgkmcnt(0)
    s_load_dword s62, s[36:37], s41
    s_mov_b64 s[4:5], s[8:9]
    s_mov_b64 s[32:33], s[30:31]
    buffer_load_ushort v26, v27, s[4:7], s60 offen
    buffer_store_dwordx4 v[108:111], v106, s[32:35], s54 offen
    s_mov_b32 s54, 0x1f8000
    s_load_dword s56, s[30:31], s54
    s_branch L_main
L_comm0:
    v_lshrrev_b32 v5, 2, v1
    v_lshlrev_b32 v5, 4, v5
    v_lshl_add_u32 v5, v4, 10, v5
    s_mov_b32 s54, 0x1f8000
    s_waitcnt lgkmcnt(0)
    s_load_dword s56, s[30:31], s54
    s_mov_b64 s[4:5], s[8:9]
    buffer_load_dwordx4 v[24:27], v5, s[4:7], 0 offen offset:0
    buffer_load_dwordx4 v[28:31], v5, s[4:7], 0 offen offset:256
    buffer_load_dwordx4 v[32:35], v5, s[4:7], 0 offen offset:512
    buffer_load_dwordx4 v[36:39], v5, s[4:7], 0 offen offset:768
    s_branch L_comm
L_ld:
    v_lshlrev_b32 v4, 1, v2
    v_xor_b32 v4, v4, v3
    v_lshlrev_b32 v4, 4, v4
    v_lshl_add_u32 v16, v2, 13, v4
    v_xor_b32 v17, 128, v16
    s_lshl_b32 s40, s53, 19
    s_lshl2_add_u32 s3, s45, s52
    s_lshl_b32 s54, s3, 8
    s_add_u32 s40, s40, s54
    s_waitcnt lgkmcnt(0)
    s_mov_b32 s4, s14
    s_mov_b32 s5, s15
    s_mov_b32 s6, 0x400000
    s_mov_b32 m0, 98304
    s_nop 0
    buffer_load_dwordx4 v16, s[4:7], s40 offen nt lds
    s_add_u32 s60, s40, 31744
    buffer_load_dwordx4 v17, s[4:7], s60 offen offset:1024 nt lds
    s_add_u32 s60, s40, 63488
    buffer_load_dwordx4 v16, s[4:7], s60 offen offset:2048 nt lds
    s_add_u32 s60, s40, 95232
    buffer_load_dwordx4 v17, s[4:7], s60 offen offset:3072 nt lds
    s_mov_b32 m0, 102400
    s_add_u32 s60, s40, 131072
    buffer_load_dwordx4 v16, s[4:7], s60 offen nt lds
    s_add_u32 s60, s40, 162816
    buffer_load_dwordx4 v17, s[4:7], s60 offen offset:1024 nt lds
    s_add_u32 s60, s40, 194560
    buffer_load_dwordx4 v16, s[4:7], s60 offen offset:2048 nt lds
    s_add_u32 s60, s40, 226304
    buffer_load_dwordx4 v17, s[4:7], s60 offen offset:3072 nt lds
    s_mov_b32 m0, 106496
    s_add_u32 s60, s40, 262144
    buffer_load_dwordx4 v16, s[4:7], s60 offen nt lds
    s_add_u32 s60, s40, 293888
    buffer_load_dwordx4 v17, s[4:7], s60 offen offset:1024 nt lds
    s_add_u32 s60, s40, 325632
    buffer_load_dwordx4 v16, s[4:7], s60 offen offset:2048 nt lds
    s_add_u32 s60, s40, 357376
    buffer_load_dwordx4 v17, s[4:7], s60 offen offset:3072 nt lds
    s_mov_b32 m0, 110592
    s_add_u32 s60, s40, 393216
    buffer_load_dwordx4 v16, s[4:7], s60 offen nt lds
    s_add_u32 s60, s40, 424960
    buffer_load_dwordx4 v17, s[4:7], s60 offen offset:1024 nt lds
    s_add_u32 s60, s40, 456704
    buffer_load_dwordx4 v16, s[4:7], s60 offen offset:2048 nt lds
    s_add_u32 s60, s40, 488448
    buffer_load_dwordx4 v17, s[4:7], s60 offen offset:3072 nt lds
    s_lshr_b32 s47, s2, 6
    s_and_b32 s48, s46, 7
    s_mov_b32 s39, 0x00020000
    v_mov_b32 v11, 0x40000000
    s_lshl_b32 s62, s46, 10
    v_lshl_add_u32 v18, v2, 8, v4
    s_lshr_b32 s54, s62, 3
    s_and_b32 s54, s54, 128
    v_xor_b32 v18, s54, v18
    v_xor_b32 v19, 128, v18
    v_xor_b32 v4, v2, v3
    v_lshlrev_b32 v4, 4, v4
    v_lshl_add_u32 v20, v2, 8, v4
    s_lshr_b32 s54, s62, 4
    s_and_b32 s54, s54, 192
    v_xor_b32 v20, s54, v20
    v_xor_b32 v21, 64, v20
    v_xor_b32 v22, 128, v20
    v_xor_b32 v23, 192, v20
    s_lshl3_add_u32 s41, s47, s45
    s_lshl_b32 s41, s41, 20
    s_lshl_b32 s54, s48, 15
    s_add_u32 s41, s41, s54
    s_add_u32 s41, s41, 786432
    s_xor_b32 s41, s41, s62
    v_lshlrev_b32 v27, 7, v1
    v_cmp_gt_u32 vcc, 16, v1
    s_nop 1
    v_cndmask_b32 v28, v11, v27, vcc
    v_cmp_gt_u32 vcc, 28, v1
    s_nop 1
    v_cndmask_b32 v29, v11, v27, vcc
    s_mov_b32 s32, s30
    s_mov_b32 s33, s31
    s_lshl_b32 s57, s46, 11
    s_add_u32 s57, s57, s51
    s_add_u32 s57, s57, 114688
    v_cmp_gt_u32 vcc, 14, v1
    s_nop 1
    v_cndmask_b32 v31, v11, v27, vcc
    s_mul_i32 s58, s46, 1792
    s_add_u32 s58, s58, s51
    s_add_u32 s55, s58, 55552
    buffer_load_dword v30, v28, s[32:35], s57 offen
    s_mov_b32 s4, s10
    s_mov_b32 s5, s11
    s_mov_b32 s6, 0x2000000
    s_xor_b32 m0, s62, 32768
    s_waitcnt vmcnt(16)
    buffer_load_dwordx4 v20, s[4:7], s41 offen nt lds
    s_xor_b32 m0, s62, 33792
    s_xor_b32 s60, s41, 1024
    s_waitcnt vmcnt(16)
    buffer_load_dwordx4 v21, s[4:7], s60 offen nt lds
    s_xor_b32 m0, s62, 34816
    s_xor_b32 s60, s41, 2048
    s_waitcnt vmcnt(16)
    buffer_load_dwordx4 v22, s[4:7], s60 offen nt lds
    s_xor_b32 m0, s62, 35840
    s_xor_b32 s60, s41, 3072
    s_waitcnt vmcnt(16)
    buffer_load_dwordx4 v23, s[4:7], s60 offen nt lds
    s_xor_b32 m0, s62, 36864
    s_xor_b32 s60, s41, 4096
    s_waitcnt vmcnt(16)
    buffer_load_dwordx4 v20, s[4:7], s60 offen nt lds
    s_xor_b32 m0, s62, 37888
    s_xor_b32 s60, s41, 5120
    s_waitcnt vmcnt(16)
    buffer_load_dwordx4 v21, s[4:7], s60 offen nt lds
    s_xor_b32 m0, s62, 38912
    s_xor_b32 s60, s41, 6144
    s_waitcnt vmcnt(16)
    buffer_load_dwordx4 v22, s[4:7], s60 offen nt lds
    v_and_b32 v4, 7, v1
    v_lshlrev_b32 v5, 1, v2
    v_xor_b32 v4, v4, v5
    v_lshlrev_b32 v4, 4, v4
    v_lshrrev_b32 v5, 3, v1
    v_mul_u32_u24 v5, 3584, v5
    v_add_u32 v24, v4, v5
    s_mul_i32 s43, s53, 229376
    s_lshl_b32 s54, s3, 7
    s_add_u32 s43, s43, s54
    s_cmp_lt_u32 s45, 7
    s_cselect_b32 s43, s43, 0x40000000
    s_sub_u32 s63, s43, 128
    v_and_b32 v4, 0xff, v16
    v_mul_u32_u24 v5, 3584, v2
    v_add_u32 v32, v4, v5
    v_xor_b32 v33, 128, v32
    v_bfe_u32 v4, v1, 2, 2
    v_lshl_add_u32 v4, v2, 3, v4
    v_and_b32 v5, 1, v2
    v_lshlrev_b32 v5, 1, v5
    v_and_b32 v6, 3, v1
    v_xor_b32 v5, v5, v6
    v_lshlrev_b32 v5, 4, v5
    v_lshl_add_u32 v25, v4, 10, v5
    s_lshl_b32 s50, s45, 19
    s_lshr_b32 s54, s46, 1
    s_and_b32 s59, s54, 3
    s_lshl_b32 s59, s59, 15
    s_lshl_b32 s54, s54, 6
    s_add_u32 s42, s50, s54
    s_xor_b32 s8, s59, 0
    s_add_u32 s8, s8, s42
    s_xor_b32 s9, s59, 32768
    s_add_u32 s9, s9, s42
    s_xor_b32 s18, s59, 65536
    s_add_u32 s18, s18, s42
    s_xor_b32 s19, s59, 98304
    s_add_u32 s19, s19, s42
    v_add_u32 v36, 0, v25
    v_add_u32 v37, 3072, v25
    v_add_u32 v38, 131072, v25
    v_add_u32 v39, 134144, v25
    v_add_u32 v40, 262144, v25
    v_add_u32 v41, 265216, v25
    v_add_u32 v42, 393216, v25
    v_add_u32 v43, 396288, v25
    s_lshl_b32 s54, s46, 14
    s_add_u32 s50, s50, s54
    s_and_b32 s54, s62, 14336
    s_xor_b32 s50, s50, s54
    v_bfe_u32 v4, v1, 3, 2
    v_lshrrev_b32 v5, 5, v1
    v_lshlrev_b32 v4, 3, v4
    v_lshl_add_u32 v4, v5, 2, v4
    v_bfe_u32 v5, v1, 1, 2
    v_add_u32 v4, v4, v5
    v_and_b32 v5, 1, v1
    v_lshlrev_b32 v5, 4, v5
    v_lshl_add_u32 v26, v4, 10, v5
    s_lshl_b32 s56, s45, 18
    s_lshl_b32 s54, s46, 5
    s_add_u32 s49, s56, s54
    s_lshl_b32 s54, s46, 13
    s_add_u32 s56, s56, s54
    s_lshr_b32 s54, s62, 1
    s_and_b32 s54, s54, 6144
    s_xor_b32 s56, s56, s54
    s_xor_b32 m0, s62, 39936
    s_xor_b32 s60, s41, 7168
    s_waitcnt vmcnt(16)
    buffer_load_dwordx4 v23, s[4:7], s60 offen nt lds
    s_xor_b32 m0, s62, 40960
    s_xor_b32 s60, s41, 8192
    s_waitcnt vmcnt(16)
    buffer_load_dwordx4 v20, s[4:7], s60 offen nt lds
    s_xor_b32 m0, s62, 41984
    s_xor_b32 s60, s41, 9216
    s_waitcnt vmcnt(16)
    buffer_load_dwordx4 v21, s[4:7], s60 offen nt lds
    s_xor_b32 m0, s62, 43008
    s_xor_b32 s60, s41, 10240
    s_waitcnt vmcnt(16)
    buffer_load_dwordx4 v22, s[4:7], s60 offen nt lds
    s_xor_b32 m0, s62, 44032
    s_xor_b32 s60, s41, 11264
    s_waitcnt vmcnt(16)
    buffer_load_dwordx4 v23, s[4:7], s60 offen nt lds
    s_xor_b32 m0, s62, 45056
    s_xor_b32 s60, s41, 12288
    s_waitcnt vmcnt(16)
    buffer_load_dwordx4 v20, s[4:7], s60 offen nt lds
    s_xor_b32 m0, s62, 46080
    s_xor_b32 s60, s41, 13312
    s_waitcnt vmcnt(16)
    buffer_load_dwordx4 v21, s[4:7], s60 offen nt lds
    s_xor_b32 m0, s62, 47104
    s_xor_b32 s60, s41, 14336
    s_waitcnt vmcnt(16)
    buffer_load_dwordx4 v22, s[4:7], s60 offen nt lds
    s_xor_b32 m0, s62, 48128
    s_xor_b32 s60, s41, 15360
    s_waitcnt vmcnt(16)
    buffer_load_dwordx4 v23, s[4:7], s60 offen nt lds
    s_barrier
    s_xor_b32 m0, s62, 49152
    s_xor_b32 s60, s41, 16384
    s_waitcnt vmcnt(16)
    buffer_load_dwordx4 v20, s[4:7], s60 offen nt lds
    s_xor_b32 m0, s62, 50176
    s_xor_b32 s60, s41, 17408
    buffer_load_dwordx4 v21, s[4:7], s60 offen nt lds
    s_xor_b32 m0, s62, 51200
    s_xor_b32 s60, s41, 18432
    s_waitcnt vmcnt(17)
    buffer_load_dwordx4 v22, s[4:7], s60 offen nt lds
    s_xor_b32 m0, s62, 52224
    s_xor_b32 s60, s41, 19456
    s_waitcnt vmcnt(17)
    buffer_load_dwordx4 v23, s[4:7], s60 offen nt lds
    s_xor_b32 m0, s62, 53248
    s_xor_b32 s60, s41, 20480
    s_waitcnt vmcnt(17)
    buffer_load_dwordx4 v20, s[4:7], s60 offen nt lds
    s_xor_b32 m0, s62, 54272
    s_xor_b32 s60, s41, 21504
    s_waitcnt vmcnt(17)
    buffer_load_dwordx4 v21, s[4:7], s60 offen nt lds
    s_xor_b32 m0, s62, 55296
    s_xor_b32 s60, s41, 22528
    s_waitcnt vmcnt(17)
    buffer_load_dwordx4 v22, s[4:7], s60 offen nt lds
    s_xor_b32 m0, s62, 56320
    s_xor_b32 s60, s41, 23552
    s_waitcnt vmcnt(17)
    buffer_load_dwordx4 v23, s[4:7], s60 offen nt lds
    s_xor_b32 m0, s62, 57344
    s_xor_b32 s60, s41, 24576
    s_waitcnt vmcnt(17)
    buffer_load_dwordx4 v20, s[4:7], s60 offen nt lds
    s_xor_b32 m0, s62, 58368
    s_xor_b32 s60, s41, 25600
    s_waitcnt vmcnt(17)
    buffer_load_dwordx4 v21, s[4:7], s60 offen nt lds
    s_xor_b32 m0, s62, 59392
    s_xor_b32 s60, s41, 26624
    s_waitcnt vmcnt(17)
    buffer_load_dwordx4 v22, s[4:7], s60 offen nt lds
    s_xor_b32 m0, s62, 60416
    s_xor_b32 s60, s41, 27648
    s_waitcnt vmcnt(17)
    buffer_load_dwordx4 v23, s[4:7], s60 offen nt lds
    s_xor_b32 m0, s62, 61440
    s_xor_b32 s60, s41, 28672
    s_waitcnt vmcnt(17)
    buffer_load_dwordx4 v20, s[4:7], s60 offen nt lds
    s_xor_b32 m0, s62, 62464
    s_xor_b32 s60, s41, 29696
    s_waitcnt vmcnt(17)
    buffer_load_dwordx4 v21, s[4:7], s60 offen nt lds
    s_xor_b32 m0, s62, 63488
    s_xor_b32 s60, s41, 30720
    s_waitcnt vmcnt(17)
    buffer_load_dwordx4 v22, s[4:7], s60 offen nt lds
    s_xor_b32 m0, s62, 64512
    s_xor_b32 s60, s41, 31744
    s_waitcnt vmcnt(17)
    buffer_load_dwordx4 v23, s[4:7], s60 offen nt lds
    s_bitcmp1_b32 s46, 0
    s_cbranch_scc1 L_ld_odd
    buffer_load_dword v30, v31, s[32:35], s58 offen
    s_mov_b32 s4, s12
    s_mov_b32 s5, s13
    s_mov_b32 s6, 0x2000000
    s_xor_b32 m0, s62, 0
    s_nop 0
    buffer_load_dwordx4 v18, s[4:7], s41 offen nt lds
    s_xor_b32 m0, s62, 1024
    s_xor_b32 s60, s41, 1024
    buffer_load_dwordx4 v19, s[4:7], s60 offen nt lds
    s_xor_b32 m0, s62, 2048
    s_xor_b32 s60, s41, 2048
    buffer_load_dwordx4 v18, s[4:7], s60 offen nt lds
    s_xor_b32 m0, s62, 3072
    s_xor_b32 s60, s41, 3072
    buffer_load_dwordx4 v19, s[4:7], s60 offen nt lds
    s_xor_b32 m0, s62, 4096
    s_xor_b32 s60, s41, 4096
    buffer_load_dwordx4 v18, s[4:7], s60 offen nt lds
    s_xor_b32 m0, s62, 5120
    s_xor_b32 s60, s41, 5120
    buffer_load_dwordx4 v19, s[4:7], s60 offen nt lds
    s_xor_b32 m0, s62, 6144
    s_xor_b32 s60, s41, 6144
    buffer_load_dwordx4 v18, s[4:7], s60 offen nt lds
    s_xor_b32 m0, s62, 7168
    s_xor_b32 s60, s41, 7168
    buffer_load_dwordx4 v19, s[4:7], s60 offen nt lds
    s_xor_b32 m0, s62, 8192
    s_xor_b32 s60, s41, 8192
    s_waitcnt vmcnt(26)
    buffer_load_dwordx4 v18, s[4:7], s60 offen nt lds
    s_xor_b32 m0, s62, 9216
    s_xor_b32 s60, s41, 9216
    s_waitcnt vmcnt(26)
    buffer_load_dwordx4 v19, s[4:7], s60 offen nt lds
    s_barrier
    s_xor_b32 m0, s62, 10240
    s_xor_b32 s60, s41, 10240
    s_waitcnt vmcnt(26)
    buffer_load_dwordx4 v18, s[4:7], s60 offen nt lds
    s_xor_b32 m0, s62, 11264
    s_xor_b32 s60, s41, 11264
    s_waitcnt vmcnt(26)
    buffer_load_dwordx4 v19, s[4:7], s60 offen nt lds
    s_xor_b32 m0, s62, 12288
    s_xor_b32 s60, s41, 12288
    buffer_load_dwordx4 v18, s[4:7], s60 offen nt lds
    s_xor_b32 m0, s62, 13312
    s_xor_b32 s60, s41, 13312
    buffer_load_dwordx4 v19, s[4:7], s60 offen nt lds
    s_xor_b32 m0, s62, 14336
    s_xor_b32 s60, s41, 14336
    buffer_load_dwordx4 v18, s[4:7], s60 offen nt lds
    s_xor_b32 m0, s62, 15360
    s_xor_b32 s60, s41, 15360
    buffer_load_dwordx4 v19, s[4:7], s60 offen nt lds
    s_xor_b32 m0, s62, 16384
    s_xor_b32 s60, s41, 16384
    buffer_load_dwordx4 v18, s[4:7], s60 offen nt lds
    s_xor_b32 m0, s62, 17408
    s_xor_b32 s60, s41, 17408
    buffer_load_dwordx4 v19, s[4:7], s60 offen nt lds
    s_xor_b32 m0, s62, 18432
    s_xor_b32 s60, s41, 18432
    buffer_load_dwordx4 v18, s[4:7], s60 offen nt lds
    s_xor_b32 m0, s62, 19456
    s_xor_b32 s60, s41, 19456
    buffer_load_dwordx4 v19, s[4:7], s60 offen nt lds
    s_xor_b32 m0, s62, 20480
    s_xor_b32 s60, s41, 20480
    buffer_load_dwordx4 v18, s[4:7], s60 offen nt lds
    s_xor_b32 m0, s62, 21504
    s_xor_b32 s60, s41, 21504
    buffer_load_dwordx4 v19, s[4:7], s60 offen nt lds
    s_xor_b32 m0, s62, 22528
    s_xor_b32 s60, s41, 22528
    buffer_load_dwordx4 v18, s[4:7], s60 offen nt lds
    s_xor_b32 m0, s62, 23552
    s_xor_b32 s60, s41, 23552
    buffer_load_dwordx4 v19, s[4:7], s60 offen nt lds
    s_xor_b32 m0, s62, 24576
    s_xor_b32 s60, s41, 24576
    buffer_load_dwordx4 v18, s[4:7], s60 offen nt lds
    s_xor_b32 m0, s62, 25600
    s_xor_b32 s60, s41, 25600
    buffer_load_dwordx4 v19, s[4:7], s60 offen nt lds
    s_xor_b32 m0, s62, 26624
    s_xor_b32 s60, s41, 26624
    buffer_load_dwordx4 v18, s[4:7], s60 offen nt lds
    s_xor_b32 m0, s62, 27648
    s_xor_b32 s60, s41, 27648
    buffer_load_dwordx4 v19, s[4:7], s60 offen nt lds
    s_xor_b32 m0, s62, 28672
    s_xor_b32 s60, s41, 28672
    buffer_load_dwordx4 v18, s[4:7], s60 offen nt lds
    s_xor_b32 m0, s62, 29696
    s_xor_b32 s60, s41, 29696
    buffer_load_dwordx4 v19, s[4:7], s60 offen nt lds
    s_xor_b32 m0, s62, 30720
    s_xor_b32 s60, s41, 30720
    buffer_load_dwordx4 v18, s[4:7], s60 offen nt lds
    s_xor_b32 m0, s62, 31744
    s_xor_b32 s60, s41, 31744
    buffer_load_dwordx4 v19, s[4:7], s60 offen nt lds
    s_waitcnt vmcnt(33)
    s_barrier
    s_barrier
    s_mov_b32 s36, s16
    s_mov_b32 s37, s17
    s_mov_b32 s38, 0x400000
    s_waitcnt vmcnt(14)
    buffer_load_dword v30, v28, s[36:39], s50 offen
    s_xor_b32 s61, s50, 2048
    s_waitcnt vmcnt(13)
    buffer_load_dword v30, v28, s[36:39], s61 offen
    s_xor_b32 s61, s50, 4096
    s_waitcnt vmcnt(12)
    buffer_load_dword v30, v28, s[36:39], s61 offen
    s_xor_b32 s61, s50, 6144
    s_waitcnt vmcnt(11)
    buffer_load_dword v30, v28, s[36:39], s61 offen
    s_xor_b32 s61, s50, 8192
    s_waitcnt vmcnt(10)
    buffer_load_dword v30, v28, s[36:39], s61 offen
    s_xor_b32 s61, s50, 10240
    s_waitcnt vmcnt(9)
    buffer_load_dword v30, v28, s[36:39], s61 offen
    s_xor_b32 s61, s50, 12288
    s_waitcnt vmcnt(8)
    buffer_load_dword v30, v28, s[36:39], s61 offen
    s_xor_b32 s61, s50, 14336
    s_waitcnt vmcnt(7)
    buffer_load_dword v30, v28, s[36:39], s61 offen
    s_barrier
    s_barrier
    s_nop 15
    s_nop 15
    s_nop 15
    s_nop 15
    s_mov_b32 m0, 65536
    s_nop 0
    buffer_load_dwordx4 v36, s[36:39], s8 offen  lds
    buffer_load_dwordx4 v37, s[36:39], s8 offen offset:1024  lds
    s_mov_b32 m0, 67584
    s_nop 0
    buffer_load_dwordx4 v36, s[36:39], s9 offen  lds
    buffer_load_dwordx4 v37, s[36:39], s9 offen offset:1024  lds
    s_mov_b32 m0, 69632
    s_nop 0
    buffer_load_dwordx4 v36, s[36:39], s18 offen  lds
    buffer_load_dwordx4 v37, s[36:39], s18 offen offset:1024  lds
    s_mov_b32 m0, 71680
    s_nop 0
    buffer_load_dwordx4 v36, s[36:39], s19 offen  lds
    buffer_load_dwordx4 v37, s[36:39], s19 offen offset:1024  lds
    s_mov_b32 m0, 73728
    s_nop 0
    buffer_load_dwordx4 v38, s[36:39], s8 offen  lds
    buffer_load_dwordx4 v39, s[36:39], s8 offen offset:1024  lds
    s_mov_b32 m0, 75776
    s_nop 0
    buffer_load_dwordx4 v38, s[36:39], s9 offen  lds
    buffer_load_dwordx4 v39, s[36:39], s9 offen offset:1024  lds
    s_mov_b32 m0, 77824
    s_nop 0
    buffer_load_dwordx4 v38, s[36:39], s18 offen  lds
    buffer_load_dwordx4 v39, s[36:39], s18 offen offset:1024  lds
    s_mov_b32 m0, 79872
    s_nop 0
    buffer_load_dwordx4 v38, s[36:39], s19 offen  lds
    buffer_load_dwordx4 v39, s[36:39], s19 offen offset:1024  lds
    s_mov_b32 m0, 81920
    s_nop 0
    buffer_load_dwordx4 v40, s[36:39], s8 offen  lds
    buffer_load_dwordx4 v41, s[36:39], s8 offen offset:1024  lds
    s_mov_b32 m0, 83968
    s_nop 0
    buffer_load_dwordx4 v40, s[36:39], s9 offen  lds
    buffer_load_dwordx4 v41, s[36:39], s9 offen offset:1024  lds
    s_mov_b32 m0, 86016
    s_nop 0
    buffer_load_dwordx4 v40, s[36:39], s18 offen  lds
    buffer_load_dwordx4 v41, s[36:39], s18 offen offset:1024  lds
    s_mov_b32 m0, 88064
    s_nop 0
    buffer_load_dwordx4 v40, s[36:39], s19 offen  lds
    buffer_load_dwordx4 v41, s[36:39], s19 offen offset:1024  lds
    s_mov_b32 m0, 90112
    s_nop 0
    buffer_load_dwordx4 v42, s[36:39], s8 offen  lds
    buffer_load_dwordx4 v43, s[36:39], s8 offen offset:1024  lds
    s_mov_b32 m0, 92160
    s_nop 0
    buffer_load_dwordx4 v42, s[36:39], s9 offen  lds
    buffer_load_dwordx4 v43, s[36:39], s9 offen offset:1024  lds
    s_mov_b32 m0, 94208
    s_nop 0
    buffer_load_dwordx4 v42, s[36:39], s18 offen  lds
    buffer_load_dwordx4 v43, s[36:39], s18 offen offset:1024  lds
    s_mov_b32 m0, 96256
    s_nop 0
    buffer_load_dwordx4 v42, s[36:39], s19 offen  lds
    buffer_load_dwordx4 v43, s[36:39], s19 offen offset:1024  lds
    s_waitcnt vmcnt(0)
    s_barrier
    s_barrier
    s_barrier
    s_mov_b32 s36, s24
    s_mov_b32 s37, s25
    s_mov_b32 s38, 0x1c0000
    s_mov_b32 m0, 131072
    s_nop 0
    buffer_load_dwordx4 v26, s[36:39], s49 offen  lds
    s_add_u32 s61, s49, 31744
    buffer_load_dwordx4 v26, s[36:39], s61 offen offset:1024  lds
    s_add_u32 s61, s49, 63488
    buffer_load_dwordx4 v26, s[36:39], s61 offen offset:2048  lds
    s_add_u32 s61, s49, 95232
    buffer_load_dwordx4 v26, s[36:39], s61 offen offset:3072  lds
    s_mov_b32 m0, 135168
    s_add_u32 s61, s49, 131072
    buffer_load_dwordx4 v26, s[36:39], s61 offen  lds
    s_add_u32 s61, s49, 162816
    buffer_load_dwordx4 v26, s[36:39], s61 offen offset:1024  lds
    s_add_u32 s61, s49, 194560
    buffer_load_dwordx4 v26, s[36:39], s61 offen offset:2048  lds
    s_add_u32 s61, s49, 226304
    buffer_load_dwordx4 v26, s[36:39], s61 offen offset:3072  lds
    s_waitcnt vmcnt(0)
    s_cmp_eq_u32 s45, 7
    s_cbranch_scc1 1
    s_barrier
    s_cmp_eq_u32 s45, 7
    s_cbranch_scc1 1
    s_barrier
    s_mov_b32 s4, s20
    s_mov_b32 s5, s21
    s_mov_b32 s6, 0x1c0000
    s_mov_b32 m0, 114688
    s_nop 0
    buffer_load_dwordx4 v24, s[4:7], s43 offen  lds
    s_add_u32 s60, s43, 27648
    buffer_load_dwordx4 v24, s[4:7], s60 offen offset:1024  lds
    s_add_u32 s60, s43, 55296
    buffer_load_dwordx4 v24, s[4:7], s60 offen offset:2048  lds
    s_add_u32 s60, s43, 82944
    buffer_load_dwordx4 v24, s[4:7], s60 offen offset:3072  lds
    s_mov_b32 m0, 118784
    s_add_u32 s60, s43, 114688
    buffer_load_dwordx4 v24, s[4:7], s60 offen  lds
    s_add_u32 s60, s43, 142336
    buffer_load_dwordx4 v24, s[4:7], s60 offen offset:1024  lds
    s_add_u32 s60, s43, 169984
    buffer_load_dwordx4 v24, s[4:7], s60 offen offset:2048  lds
    s_add_u32 s60, s43, 197632
    buffer_load_dwordx4 v24, s[4:7], s60 offen offset:3072  lds
    s_mov_b32 s4, s22
    s_mov_b32 s5, s23
    s_mov_b32 s6, 0x1c0000
    s_mov_b32 m0, 122880
    s_nop 0
    buffer_load_dwordx4 v24, s[4:7], s43 offen  lds
    s_add_u32 s60, s43, 27648
    buffer_load_dwordx4 v24, s[4:7], s60 offen offset:1024  lds
    s_add_u32 s60, s43, 55296
    buffer_load_dwordx4 v24, s[4:7], s60 offen offset:2048  lds
    s_add_u32 s60, s43, 82944
    buffer_load_dwordx4 v24, s[4:7], s60 offen offset:3072  lds
    s_mov_b32 m0, 126976
    s_add_u32 s60, s43, 114688
    buffer_load_dwordx4 v24, s[4:7], s60 offen  lds
    s_add_u32 s60, s43, 142336
    buffer_load_dwordx4 v24, s[4:7], s60 offen offset:1024  lds
    s_add_u32 s60, s43, 169984
    buffer_load_dwordx4 v24, s[4:7], s60 offen offset:2048  lds
    s_add_u32 s60, s43, 197632
    buffer_load_dwordx4 v24, s[4:7], s60 offen offset:3072  lds
    s_waitcnt vmcnt(0)
    s_endpgm
L_ld_odd:
    buffer_load_dword v30, v31, s[32:35], s58 offen
    s_mov_b32 s4, s12
    s_mov_b32 s5, s13
    s_mov_b32 s6, 0x2000000
    s_xor_b32 m0, s62, 0
    s_nop 0
    buffer_load_dwordx4 v18, s[4:7], s41 offen nt lds
    s_xor_b32 m0, s62, 1024
    s_xor_b32 s60, s41, 1024
    buffer_load_dwordx4 v19, s[4:7], s60 offen nt lds
    s_xor_b32 m0, s62, 2048
    s_xor_b32 s60, s41, 2048
    buffer_load_dwordx4 v18, s[4:7], s60 offen nt lds
    s_xor_b32 m0, s62, 3072
    s_xor_b32 s60, s41, 3072
    buffer_load_dwordx4 v19, s[4:7], s60 offen nt lds
    s_xor_b32 m0, s62, 4096
    s_xor_b32 s60, s41, 4096
    buffer_load_dwordx4 v18, s[4:7], s60 offen nt lds
    s_xor_b32 m0, s62, 5120
    s_xor_b32 s60, s41, 5120
    buffer_load_dwordx4 v19, s[4:7], s60 offen nt lds
    s_xor_b32 m0, s62, 6144
    s_xor_b32 s60, s41, 6144
    buffer_load_dwordx4 v18, s[4:7], s60 offen nt lds
    s_xor_b32 m0, s62, 7168
    s_xor_b32 s60, s41, 7168
    buffer_load_dwordx4 v19, s[4:7], s60 offen nt lds
    s_xor_b32 m0, s62, 8192
    s_xor_b32 s60, s41, 8192
    s_waitcnt vmcnt(26)
    buffer_load_dwordx4 v18, s[4:7], s60 offen nt lds
    s_xor_b32 m0, s62, 9216
    s_xor_b32 s60, s41, 9216
    s_waitcnt vmcnt(26)
    buffer_load_dwordx4 v19, s[4:7], s60 offen nt lds
    s_barrier
    s_xor_b32 m0, s62, 10240
    s_xor_b32 s60, s41, 10240
    s_waitcnt vmcnt(26)
    buffer_load_dwordx4 v18, s[4:7], s60 offen nt lds
    s_xor_b32 m0, s62, 11264
    s_xor_b32 s60, s41, 11264
    s_waitcnt vmcnt(26)
    buffer_load_dwordx4 v19, s[4:7], s60 offen nt lds
    s_xor_b32 m0, s62, 12288
    s_xor_b32 s60, s41, 12288
    buffer_load_dwordx4 v18, s[4:7], s60 offen nt lds
    s_xor_b32 m0, s62, 13312
    s_xor_b32 s60, s41, 13312
    buffer_load_dwordx4 v19, s[4:7], s60 offen nt lds
    s_xor_b32 m0, s62, 14336
    s_xor_b32 s60, s41, 14336
    buffer_load_dwordx4 v18, s[4:7], s60 offen nt lds
    s_xor_b32 m0, s62, 15360
    s_xor_b32 s60, s41, 15360
    buffer_load_dwordx4 v19, s[4:7], s60 offen nt lds
    s_xor_b32 m0, s62, 16384
    s_xor_b32 s60, s41, 16384
    buffer_load_dwordx4 v18, s[4:7], s60 offen nt lds
    s_xor_b32 m0, s62, 17408
    s_xor_b32 s60, s41, 17408
    buffer_load_dwordx4 v19, s[4:7], s60 offen nt lds
    s_xor_b32 m0, s62, 18432
    s_xor_b32 s60, s41, 18432
    buffer_load_dwordx4 v18, s[4:7], s60 offen nt lds
    s_xor_b32 m0, s62, 19456
    s_xor_b32 s60, s41, 19456
    buffer_load_dwordx4 v19, s[4:7], s60 offen nt lds
    s_xor_b32 m0, s62, 20480
    s_xor_b32 s60, s41, 20480
    buffer_load_dwordx4 v18, s[4:7], s60 offen nt lds
    s_xor_b32 m0, s62, 21504
    s_xor_b32 s60, s41, 21504
    buffer_load_dwordx4 v19, s[4:7], s60 offen nt lds
    s_xor_b32 m0, s62, 22528
    s_xor_b32 s60, s41, 22528
    buffer_load_dwordx4 v18, s[4:7], s60 offen nt lds
    s_xor_b32 m0, s62, 23552
    s_xor_b32 s60, s41, 23552
    buffer_load_dwordx4 v19, s[4:7], s60 offen nt lds
    s_xor_b32 m0, s62, 24576
    s_xor_b32 s60, s41, 24576
    buffer_load_dwordx4 v18, s[4:7], s60 offen nt lds
    s_xor_b32 m0, s62, 25600
    s_xor_b32 s60, s41, 25600
    buffer_load_dwordx4 v19, s[4:7], s60 offen nt lds
    s_xor_b32 m0, s62, 26624
    s_xor_b32 s60, s41, 26624
    buffer_load_dwordx4 v18, s[4:7], s60 offen nt lds
    s_xor_b32 m0, s62, 27648
    s_xor_b32 s60, s41, 27648
    buffer_load_dwordx4 v19, s[4:7], s60 offen nt lds
    s_xor_b32 m0, s62, 28672
    s_xor_b32 s60, s41, 28672
    buffer_load_dwordx4 v18, s[4:7], s60 offen nt lds
    s_xor_b32 m0, s62, 29696
    s_xor_b32 s60, s41, 29696
    buffer_load_dwordx4 v19, s[4:7], s60 offen nt lds
    s_xor_b32 m0, s62, 30720
    s_xor_b32 s60, s41, 30720
    buffer_load_dwordx4 v18, s[4:7], s60 offen nt lds
    s_xor_b32 m0, s62, 31744
    s_xor_b32 s60, s41, 31744
    buffer_load_dwordx4 v19, s[4:7], s60 offen nt lds
    s_waitcnt vmcnt(33)
    s_barrier
    s_barrier
    s_mov_b32 s36, s16
    s_mov_b32 s37, s17
    s_mov_b32 s38, 0x400000
    s_waitcnt vmcnt(14)
    buffer_load_dword v30, v28, s[36:39], s50 offen
    s_xor_b32 s61, s50, 2048
    s_waitcnt vmcnt(13)
    buffer_load_dword v30, v28, s[36:39], s61 offen
    s_xor_b32 s61, s50, 4096
    s_waitcnt vmcnt(12)
    buffer_load_dword v30, v28, s[36:39], s61 offen
    s_xor_b32 s61, s50, 6144
    s_waitcnt vmcnt(11)
    buffer_load_dword v30, v28, s[36:39], s61 offen
    s_xor_b32 s61, s50, 8192
    s_waitcnt vmcnt(10)
    buffer_load_dword v30, v28, s[36:39], s61 offen
    s_xor_b32 s61, s50, 10240
    s_waitcnt vmcnt(9)
    buffer_load_dword v30, v28, s[36:39], s61 offen
    s_xor_b32 s61, s50, 12288
    s_waitcnt vmcnt(8)
    buffer_load_dword v30, v28, s[36:39], s61 offen
    s_xor_b32 s61, s50, 14336
    s_waitcnt vmcnt(7)
    buffer_load_dword v30, v28, s[36:39], s61 offen
    s_barrier
    s_barrier
    s_nop 15
    s_nop 15
    s_nop 15
    s_nop 15
    s_mov_b32 s4, s20
    s_mov_b32 s5, s21
    s_mov_b32 s6, 0x1c0000
    s_mov_b32 m0, 65536
    s_nop 0
    buffer_load_dwordx4 v32, s[4:7], s63 offen  lds
    s_add_u32 s60, s63, 13312
    buffer_load_dwordx4 v33, s[4:7], s60 offen offset:1024  lds
    s_add_u32 s60, s63, 26624
    buffer_load_dwordx4 v32, s[4:7], s60 offen offset:2048  lds
    s_add_u32 s60, s63, 39936
    buffer_load_dwordx4 v33, s[4:7], s60 offen offset:3072  lds
    s_mov_b32 m0, 69632
    s_add_u32 s60, s63, 57344
    buffer_load_dwordx4 v32, s[4:7], s60 offen  lds
    s_add_u32 s60, s63, 70656
    buffer_load_dwordx4 v33, s[4:7], s60 offen offset:1024  lds
    s_add_u32 s60, s63, 83968
    buffer_load_dwordx4 v32, s[4:7], s60 offen offset:2048  lds
    s_add_u32 s60, s63, 97280
    buffer_load_dwordx4 v33, s[4:7], s60 offen offset:3072  lds
    s_mov_b32 m0, 73728
    s_add_u32 s60, s63, 114688
    buffer_load_dwordx4 v32, s[4:7], s60 offen  lds
    s_add_u32 s60, s63, 128000
    buffer_load_dwordx4 v33, s[4:7], s60 offen offset:1024  lds
    s_add_u32 s60, s63, 141312
    buffer_load_dwordx4 v32, s[4:7], s60 offen offset:2048  lds
    s_add_u32 s60, s63, 154624
    buffer_load_dwordx4 v33, s[4:7], s60 offen offset:3072  lds
    s_mov_b32 m0, 77824
    s_add_u32 s60, s63, 172032
    buffer_load_dwordx4 v32, s[4:7], s60 offen  lds
    s_add_u32 s60, s63, 185344
    buffer_load_dwordx4 v33, s[4:7], s60 offen offset:1024  lds
    s_add_u32 s60, s63, 198656
    buffer_load_dwordx4 v32, s[4:7], s60 offen offset:2048  lds
    s_add_u32 s60, s63, 211968
    buffer_load_dwordx4 v33, s[4:7], s60 offen offset:3072  lds
    s_mov_b32 s4, s22
    s_mov_b32 s5, s23
    s_mov_b32 s6, 0x1c0000
    s_mov_b32 m0, 81920
    s_nop 0
    buffer_load_dwordx4 v32, s[4:7], s63 offen  lds
    s_add_u32 s60, s63, 13312
    buffer_load_dwordx4 v33, s[4:7], s60 offen offset:1024  lds
    s_add_u32 s60, s63, 26624
    buffer_load_dwordx4 v32, s[4:7], s60 offen offset:2048  lds
    s_add_u32 s60, s63, 39936
    buffer_load_dwordx4 v33, s[4:7], s60 offen offset:3072  lds
    s_mov_b32 m0, 86016
    s_add_u32 s60, s63, 57344
    buffer_load_dwordx4 v32, s[4:7], s60 offen  lds
    s_add_u32 s60, s63, 70656
    buffer_load_dwordx4 v33, s[4:7], s60 offen offset:1024  lds
    s_add_u32 s60, s63, 83968
    buffer_load_dwordx4 v32, s[4:7], s60 offen offset:2048  lds
    s_add_u32 s60, s63, 97280
    buffer_load_dwordx4 v33, s[4:7], s60 offen offset:3072  lds
    s_mov_b32 m0, 90112
    s_add_u32 s60, s63, 114688
    s_waitcnt vmcnt(31)
    buffer_load_dwordx4 v32, s[4:7], s60 offen  lds
    s_add_u32 s60, s63, 128000
    buffer_load_dwordx4 v33, s[4:7], s60 offen offset:1024  lds
    s_add_u32 s60, s63, 141312
    s_waitcnt vmcnt(32)
    buffer_load_dwordx4 v32, s[4:7], s60 offen offset:2048  lds
    s_add_u32 s60, s63, 154624
    buffer_load_dwordx4 v33, s[4:7], s60 offen offset:3072  lds
    s_mov_b32 m0, 94208
    s_add_u32 s60, s63, 172032
    s_waitcnt vmcnt(33)
    buffer_load_dwordx4 v32, s[4:7], s60 offen  lds
    s_add_u32 s60, s63, 185344
    buffer_load_dwordx4 v33, s[4:7], s60 offen offset:1024  lds
    s_add_u32 s60, s63, 198656
    s_waitcnt vmcnt(34)
    buffer_load_dwordx4 v32, s[4:7], s60 offen offset:2048  lds
    s_add_u32 s60, s63, 211968
    buffer_load_dwordx4 v33, s[4:7], s60 offen offset:3072  lds
    s_mov_b32 s36, s24
    s_mov_b32 s37, s25
    s_mov_b32 s38, 0x1c0000
    s_waitcnt vmcnt(35)
    buffer_load_dword v30, v28, s[36:39], s56 offen
    s_xor_b32 s61, s56, 2048
    s_waitcnt vmcnt(35)
    buffer_load_dword v30, v28, s[36:39], s61 offen
    s_xor_b32 s61, s56, 4096
    s_waitcnt vmcnt(35)
    buffer_load_dword v30, v28, s[36:39], s61 offen
    s_xor_b32 s61, s56, 6144
    s_waitcnt vmcnt(35)
    buffer_load_dword v30, v28, s[36:39], s61 offen
    s_xor_b32 s61, s56, 8192
    s_waitcnt vmcnt(34)
    buffer_load_dword v30, v28, s[36:39], s61 offen
    s_xor_b32 s61, s56, 10240
    s_waitcnt vmcnt(33)
    buffer_load_dword v30, v28, s[36:39], s61 offen
    s_xor_b32 s61, s56, 12288
    s_waitcnt vmcnt(32)
    buffer_load_dword v30, v28, s[36:39], s61 offen
    s_xor_b32 s61, s56, 14336
    s_waitcnt vmcnt(31)
    buffer_load_dword v30, v28, s[36:39], s61 offen
    s_waitcnt vmcnt(28)
    buffer_load_dword v30, v29, s[32:35], s55 offen
    s_waitcnt vmcnt(9)
    s_barrier
    s_mov_b32 m0, 131072
    s_waitcnt vmcnt(0)
    buffer_load_dwordx4 v26, s[36:39], s49 offen  lds
    s_add_u32 s61, s49, 31744
    buffer_load_dwordx4 v26, s[36:39], s61 offen offset:1024  lds
    s_add_u32 s61, s49, 63488
    buffer_load_dwordx4 v26, s[36:39], s61 offen offset:2048  lds
    s_add_u32 s61, s49, 95232
    buffer_load_dwordx4 v26, s[36:39], s61 offen offset:3072  lds
    s_mov_b32 m0, 135168
    s_add_u32 s61, s49, 131072
    buffer_load_dwordx4 v26, s[36:39], s61 offen  lds
    s_add_u32 s61, s49, 162816
    buffer_load_dwordx4 v26, s[36:39], s61 offen offset:1024  lds
    s_add_u32 s61, s49, 194560
    buffer_load_dwordx4 v26, s[36:39], s61 offen offset:2048  lds
    s_add_u32 s61, s49, 226304
    buffer_load_dwordx4 v26, s[36:39], s61 offen offset:3072  lds
    s_barrier
    s_waitcnt vmcnt(0)
    s_cmp_eq_u32 s45, 7
    s_cbranch_scc1 1
    s_barrier
    s_cmp_eq_u32 s45, 7
    s_cbranch_scc1 1
    s_barrier
    s_mov_b32 s36, s16
    s_mov_b32 s37, s17
    s_mov_b32 s38, 0x400000
    s_mov_b32 m0, 65536
    s_nop 0
    buffer_load_dwordx4 v36, s[36:39], s8 offen  lds
    buffer_load_dwordx4 v37, s[36:39], s8 offen offset:1024  lds
    s_mov_b32 m0, 67584
    s_nop 0
    buffer_load_dwordx4 v36, s[36:39], s9 offen  lds
    buffer_load_dwordx4 v37, s[36:39], s9 offen offset:1024  lds
    s_mov_b32 m0, 69632
    s_nop 0
    buffer_load_dwordx4 v36, s[36:39], s18 offen  lds
    buffer_load_dwordx4 v37, s[36:39], s18 offen offset:1024  lds
    s_mov_b32 m0, 71680
    s_nop 0
    buffer_load_dwordx4 v36, s[36:39], s19 offen  lds
    buffer_load_dwordx4 v37, s[36:39], s19 offen offset:1024  lds
    s_mov_b32 m0, 73728
    s_nop 0
    buffer_load_dwordx4 v38, s[36:39], s8 offen  lds
    buffer_load_dwordx4 v39, s[36:39], s8 offen offset:1024  lds
    s_mov_b32 m0, 75776
    s_nop 0
    buffer_load_dwordx4 v38, s[36:39], s9 offen  lds
    buffer_load_dwordx4 v39, s[36:39], s9 offen offset:1024  lds
    s_mov_b32 m0, 77824
    s_nop 0
    buffer_load_dwordx4 v38, s[36:39], s18 offen  lds
    buffer_load_dwordx4 v39, s[36:39], s18 offen offset:1024  lds
    s_mov_b32 m0, 79872
    s_nop 0
    buffer_load_dwordx4 v38, s[36:39], s19 offen  lds
    buffer_load_dwordx4 v39, s[36:39], s19 offen offset:1024  lds
    s_nop 15
    s_nop 15
    s_nop 15
    s_nop 15
    s_nop 7
    s_mov_b32 m0, 81920
    s_nop 0
    buffer_load_dwordx4 v40, s[36:39], s8 offen  lds
    buffer_load_dwordx4 v41, s[36:39], s8 offen offset:1024  lds
    s_mov_b32 m0, 83968
    s_nop 0
    buffer_load_dwordx4 v40, s[36:39], s9 offen  lds
    buffer_load_dwordx4 v41, s[36:39], s9 offen offset:1024  lds
    s_mov_b32 m0, 86016
    s_nop 0
    buffer_load_dwordx4 v40, s[36:39], s18 offen  lds
    buffer_load_dwordx4 v41, s[36:39], s18 offen offset:1024  lds
    s_mov_b32 m0, 88064
    s_nop 0
    buffer_load_dwordx4 v40, s[36:39], s19 offen  lds
    buffer_load_dwordx4 v41, s[36:39], s19 offen offset:1024  lds
    s_mov_b32 m0, 90112
    s_nop 0
    buffer_load_dwordx4 v42, s[36:39], s8 offen  lds
    buffer_load_dwordx4 v43, s[36:39], s8 offen offset:1024  lds
    s_mov_b32 m0, 92160
    s_nop 0
    buffer_load_dwordx4 v42, s[36:39], s9 offen  lds
    buffer_load_dwordx4 v43, s[36:39], s9 offen offset:1024  lds
    s_mov_b32 m0, 94208
    s_nop 0
    buffer_load_dwordx4 v42, s[36:39], s18 offen  lds
    buffer_load_dwordx4 v43, s[36:39], s18 offen offset:1024  lds
    s_mov_b32 m0, 96256
    s_nop 0
    buffer_load_dwordx4 v42, s[36:39], s19 offen  lds
    buffer_load_dwordx4 v43, s[36:39], s19 offen offset:1024  lds
    s_waitcnt vmcnt(0)
    s_endpgm
L_main:
    s_lshr_b32 s47, s2, 6
    s_and_b32 s48, s46, 7
    s_mov_b32 s39, 0x00020000
    v_mov_b32 v11, 0x40000000
    s_mul_i32 s59, s45, 0x100
    s_add_u32 s59, s59, 0x1e0000
    s_mov_b32 s49, 0x20000
    s_mov_b32 s50, -2
    s_mov_b32 s58, 0
    s_mov_b32 s38, 0x500000
    s_mov_b32 s40, 0
    s_mul_i32 s63, s44, 8192
    v_lshlrev_b32 v7, 2, v1
    s_mov_b64 s[32:33], s[30:31]
    s_mov_b64 s[36:37], s[30:31]
    v_mov_b32 v4, 0
    v_cmp_eq_u32 vcc, 0, v1
    s_nop 1
    v_cndmask_b32 v9, v11, v4, vcc
    v_mov_b32 v10, 0xff
    v_lshlrev_b32 v5, 4, v3
    v_lshl_add_u32 v5, v2, 6, v5
    v_cmp_gt_u32 vcc, 4, v3
    v_mov_b32 v6, 512
    s_nop 0
    v_cndmask_b32 v12, v6, v5, vcc
    v_add_u32 v12, 150016, v12
    v_xor_b32 v4, v2, v3
    v_lshlrev_b32 v4, 4, v4
    v_lshl_add_u32 v28, v3, 8, v4
    v_add_u32 v28, s63, v28
    v_and_b32 v112, 3, v1
    v_bfe_u32 v113, v1, 2, 2
    v_lshrrev_b32 v114, 2, v1
    s_lshr_b32 s54, s44, 1
    s_lshl_b32 s54, s54, 8
    s_and_b32 s3, s44, 1
    s_lshl_b32 s3, s3, 3
    s_add_u32 s54, s54, s3
    s_add_u32 s54, s54, 150016
    v_lshl_add_u32 v14, v2, 1, s54
    v_lshl_add_u32 v14, v112, 6, v14
    v_lshl_add_u32 v14, v113, 4, v14
    v_lshlrev_b32 v4, 4, v2
    v_lshl_add_u32 v5, v3, 7, v4
    v_cmp_gt_u32 vcc, 4, v3
    s_nop 1
    v_cndmask_b32 v16, v11, v5, vcc
    v_cmp_eq_u32 vcc, 0, v3
    s_nop 1
    v_cndmask_b32 v18, v11, v4, vcc
    v_and_b32 v4, 7, v3
    v_lshlrev_b32 v4, 4, v4
    v_lshl_add_u32 v4, v2, 7, v4
    v_lshrrev_b32 v5, 3, v3
    v_lshl_add_u32 v4, v5, 11, v4
    v_cmp_gt_u32 vcc, 32, v1
    s_nop 1
    v_cndmask_b32 v17, v11, v4, vcc
    s_mul_i32 s54, s44, 2112
    s_add_u32 s54, s54, 139264
    v_mul_u32_u24 v19, 528, v112
    v_lshl_add_u32 v19, v113, 6, v19
    v_lshl_add_u32 v19, v2, 4, v19
    v_add_u32 v19, s54, v19
    s_lshl_b32 s54, s44, 2
    s_add_u32 s54, s54, 147712
    v_cmp_gt_u32 vcc, 4, v1
    v_mov_b32 v20, 128
    s_nop 0
    v_cndmask_b32 v20, v20, v8, vcc
    v_add_u32 v20, s54, v20
    s_mul_i32 s54, s44, 528
    s_add_u32 s54, s54, 139264
    v_lshl_add_u32 v21, v1, 3, s54
    s_lshl_b32 s54, s44, 4
    s_add_u32 s54, s54, 147712
    v_mov_b32 v22, s54
    v_lshlrev_b32 v23, 2, v112
    v_lshl_add_u32 v23, v114, 8, v23
    v_lshlrev_b32 v24, 5, v2
    v_lshl_add_u32 v24, v112, 3, v24
    v_and_b32 v4, 4, v1
    v_add_u32 v24, v4, v24
    s_lshl_b32 s54, s44, 8
    s_add_u32 s54, s54, 147968
    v_add_u32 v25, s54, v7
    s_lshr_b32 s54, s46, 1
    s_and_b32 s54, s54, 3
    s_lshl_b32 s54, s54, 10
    v_add_u32 v31, s54, v8
    v_xor_b32 v32, 1024, v31
    v_xor_b32 v33, 2048, v31
    v_xor_b32 v34, 3072, v31
    v_lshlrev_b32 v30, 4, v112
    v_add_u32 v30, 147712, v30
    v_lshlrev_b32 v29, 3, v112
    v_lshl_add_u32 v29, v114, 8, v29
    v_and_b32 v4, 7, v114
    v_lshl_add_u32 v29, v4, 5, v29
    v_mov_b32 v36, 0x3f803f80
    v_mov_b32 v37, 0x3f803f80
    v_mov_b32 v38, 0x3f803f80
    v_mov_b32 v39, 0x3f803f80
    v_mov_b32 v88, 0
    v_mov_b32 v89, 0
    v_mov_b32 v90, 0
    v_mov_b32 v91, 0
    v_mov_b32 v92, 0
    v_mov_b32 v93, 0
    v_mov_b32 v94, 0
    v_mov_b32 v95, 0
    v_mov_b32 v96, 0
    v_mov_b32 v97, 0
    v_mov_b32 v98, 0
    v_mov_b32 v99, 0
    v_mov_b32 v100, 0
    v_mov_b32 v101, 0
    v_mov_b32 v102, 0
    v_mov_b32 v103, 0
    s_waitcnt vmcnt(1)
    ds_write_b16 v14, v26
    v_lshlrev_b32 v26, 16, v26
    s_waitcnt vmcnt(0) lgkmcnt(0)
    s_barrier
    s_lshl_b32 s54, s44, 6
    v_xor_b32 v5, s54, v29
    v_add_u32 v5, 98304, v5
    v_xor_b32 v6, 32, v5
    ds_read_b64_tr_b16 a[0:1], v5 offset:0
    ds_read_b64_tr_b16 a[2:3], v5 offset:4096
    ds_read_b64_tr_b16 a[4:5], v5 offset:8192
    ds_read_b64_tr_b16 a[6:7], v5 offset:12288
    ds_read_b64_tr_b16 a[8:9], v6 offset:0
    ds_read_b64_tr_b16 a[10:11], v6 offset:4096
    ds_read_b64_tr_b16 a[12:13], v6 offset:8192
    ds_read_b64_tr_b16 a[14:15], v6 offset:12288
    ds_read_b128 v[116:119], v12
    ds_read_b128 v[120:123], v12 offset:256
    v_lshlrev_b32 v4, 3, v112
    v_add_u32 v4, 154112, v4
    ds_read_b64 v[104:105], v4
    v_add_u32 v29, s63, v29
    s_add_u32 s56, s56, 1
    s_getreg_b32 s3, hwreg(HW_REG_XCC_ID, 0, 4)
    s_lshl_b32 s3, s3, 8
    s_and_b32 s57, s56, 0xff
    s_or_b32 s57, s57, s3
    s_lshl2_add_u32 s60, s52, s44
    s_lshl_b32 s60, s60, 12
    s_lshl_b32 s3, s53, 8
    s_add_u32 s60, s60, s3
    s_waitcnt lgkmcnt(0)
    v_mfma_f32_16x16x32_bf16 v[72:75], a[0:3], v[116:119], 0
    v_mfma_f32_16x16x32_bf16 v[72:75], a[4:7], v[120:123], v[72:75]
    v_mfma_f32_16x16x32_bf16 v[76:79], a[8:11], v[116:119], 0
    v_mfma_f32_16x16x32_bf16 v[76:79], a[12:15], v[120:123], v[76:79]
    v_mfma_f32_16x16x32_bf16 v[80:83], a[0:3], v[36:39], 0
    v_mfma_f32_16x16x32_bf16 v[80:83], a[4:7], v[36:39], v[80:83]
    v_mfma_f32_16x16x32_bf16 v[84:87], a[8:11], v[36:39], 0
    v_mfma_f32_16x16x32_bf16 v[84:87], a[12:15], v[36:39], v[84:87]
    v_mov_b32 v6, 0xfff
    s_nop 6
    v_pk_fma_f32 v[72:73], v[104:105], v[80:81], v[72:73] op_sel_hi:[0,1,1] neg_lo:[1,0,0] neg_hi:[1,0,0]
    v_pk_fma_f32 v[74:75], v[104:105], v[82:83], v[74:75] op_sel_hi:[0,1,1] neg_lo:[1,0,0] neg_hi:[1,0,0]
    v_pk_fma_f32 v[76:77], v[104:105], v[84:85], v[76:77] op_sel_hi:[0,1,1] neg_lo:[1,0,0] neg_hi:[1,0,0]
    v_pk_fma_f32 v[78:79], v[104:105], v[86:87], v[78:79] op_sel_hi:[0,1,1] neg_lo:[1,0,0] neg_hi:[1,0,0]
    v_pk_mul_f32 v[72:73], v[72:73], v[104:105] op_sel:[0,1] op_sel_hi:[1,1]
    v_pk_mul_f32 v[74:75], v[74:75], v[104:105] op_sel:[0,1] op_sel_hi:[1,1]
    v_pk_mul_f32 v[76:77], v[76:77], v[104:105] op_sel:[0,1] op_sel_hi:[1,1]
    v_pk_mul_f32 v[78:79], v[78:79], v[104:105] op_sel:[0,1] op_sel_hi:[1,1]
    v_bfi_b32 v72, v6, s57, v72
    v_bfi_b32 v76, v6, s57, v76
    s_lshl_b32 s3, s53, 8
    s_add_u32 s54, s60, s3
    s_add_u32 s54, s54, s51
    s_add_u32 s54, s54, 114688
    buffer_store_dwordx4 v[72:75], v16, s[32:35], s54 offen offset:0
    buffer_store_dwordx4 v[76:79], v16, s[32:35], s54 offen offset:64
    v_lshlrev_b32 v4, 4, v3
    v_lshl_add_u32 v4, v2, 11, v4
    v_cmp_gt_u32 vcc, 32, v1
    s_nop 1
    v_cndmask_b32 v16, v11, v4, vcc
    v_and_b32 v4, 3, v3
    v_lshlrev_b32 v4, 4, v4
    v_lshl_add_u32 v4, v2, 6, v4
    v_add_u32 v4, 150016, v4
    v_lshrrev_b32 v5, 2, v3
    v_mov_b32 v6, 151040
    v_cmp_eq_u32 vcc, 0, v5
    s_nop 1
    v_cndmask_b32 v12, v6, v4, vcc
    v_cmp_eq_u32 vcc, 1, v5
    s_nop 1
    v_cndmask_b32 v15, v6, v4, vcc
    s_mul_i32 s54, s44, 81
    s_add_u32 s54, s54, s2
    s_and_b32 s10, s54, 63
    s_lshl_b32 s10, s10, 7
    s_bfe_u32 s54, s54, 0x20006
    s_lshl_b32 s54, s54, 14
    s_add_u32 s10, s10, s54
    s_add_u32 s10, s10, 0x1e4000
    s_add_u32 s11, s10, 8192
    s_load_dword s54, s[30:31], s10 glc
    s_load_dword s19, s[30:31], s11 glc
    s_barrier
    s_waitcnt lgkmcnt(0)
    s_not_b32 s55, s19
    s_load_dword s54, s[30:31], s10 glc
    s_load_dword s55, s[30:31], s11 glc
    s_waitcnt lgkmcnt(1)
    s_cmp_eq_u32 s55, s19
    s_cselect_b32 s18, 1, 0
    s_waitcnt lgkmcnt(0)
    s_cmp_lg_u32 s44, 0
    s_cbranch_scc1 L_warm1
    s_call_b64 s[12:13], L_pad0
    s_call_b64 s[12:13], L_pad4
    s_call_b64 s[12:13], L_pad8
    s_call_b64 s[12:13], L_pad12
    s_call_b64 s[12:13], L_pad16
    s_call_b64 s[12:13], L_pad20
    s_call_b64 s[12:13], L_pad24
    s_call_b64 s[12:13], L_pad28
    s_branch L_warm4
L_warm1:
    s_cmp_lg_u32 s44, 1
    s_cbranch_scc1 L_warm2
    s_call_b64 s[12:13], L_pad1
    s_call_b64 s[12:13], L_pad5
    s_call_b64 s[12:13], L_pad9
    s_call_b64 s[12:13], L_pad13
    s_call_b64 s[12:13], L_pad17
    s_call_b64 s[12:13], L_pad21
    s_call_b64 s[12:13], L_pad25
    s_branch L_warm4
L_warm2:
    s_cmp_lg_u32 s44, 2
    s_cbranch_scc1 L_warm3
    s_call_b64 s[12:13], L_pad2
    s_call_b64 s[12:13], L_pad6
    s_call_b64 s[12:13], L_pad10
    s_call_b64 s[12:13], L_pad14
    s_call_b64 s[12:13], L_pad18
    s_call_b64 s[12:13], L_pad22
    s_call_b64 s[12:13], L_pad26
    s_branch L_warm4
L_warm3:
    s_call_b64 s[12:13], L_pad3
    s_call_b64 s[12:13], L_pad7
    s_call_b64 s[12:13], L_pad11
    s_call_b64 s[12:13], L_pad15
    s_call_b64 s[12:13], L_pad19
    s_call_b64 s[12:13], L_pad23
    s_call_b64 s[12:13], L_pad27
    s_nop 0
    s_nop 0
    s_nop 0
    s_nop 0
    s_nop 0
    s_nop 0
    s_nop 0
    s_nop 0
    s_nop 0
    s_nop 0
    s_nop 0
    s_nop 0
L_warm4:
    s_barrier
    ds_read_b128 a[32:35], v28 offset:32768
    v_xor_b32 v4, 64, v28
    ds_read_b128 a[36:39], v4 offset:32768
    v_xor_b32 v4, 128, v28
    ds_read_b128 a[40:43], v4 offset:32768
    v_xor_b32 v4, 192, v28
    ds_read_b128 a[44:47], v4 offset:32768
    ds_read_b128 a[48:51], v28 offset:36864
    v_xor_b32 v4, 64, v28
    ds_read_b128 a[52:55], v4 offset:36864
    v_xor_b32 v4, 128, v28
    ds_read_b128 a[56:59], v4 offset:36864
    v_xor_b32 v4, 192, v28
    ds_read_b128 a[60:63], v4 offset:36864
    s_waitcnt lgkmcnt(0)
    v_bfe_u32 v4, v1, 3, 2
    v_xor_b32 v4, s44, v4
    v_lshlrev_b32 v4, 5, v4
    v_lshrrev_b32 v6, 2, v1
    v_lshl_add_u32 v4, v6, 7, v4
    v_and_b32 v6, 3, v1
    v_lshl_add_u32 v4, v6, 3, v4
    v_add_u32 v28, 114688, v4
    s_branch L_over0
L_pad0:
    s_setpc_b64 s[12:13]
L_over0:
    s_barrier
    v_add_u32 v4, 153088, v8
    v_mov_b32 v5, 154144
    ds_read_b128 v[40:43], v4
    ds_read_b32 v5, v5
    s_waitcnt lgkmcnt(0)
    v_mfma_f32_16x16x32_bf16 v[72:75], a[32:35], v[40:43], 0
    v_readfirstlane_b32 s40, v5
    v_mov_b32_dpp v112, v40 row_shl:4 row_mask:0xf bank_mask:0xf
    v_mov_b32_dpp v113, v41 row_shl:4 row_mask:0xf bank_mask:0xf
    v_mfma_f32_16x16x32_bf16 v[76:79], a[48:51], v[40:43], 0
    v_mov_b32_dpp v114, v42 row_shl:4 row_mask:0xf bank_mask:0xf
    v_mov_b32_dpp v115, v43 row_shl:4 row_mask:0xf bank_mask:0xf
    s_nop 1
    v_mfma_f32_16x16x32_bf16 v[72:75], a[36:39], v[112:115], v[72:75]
    v_mov_b32_dpp v116, v40 row_shl:8 row_mask:0xf bank_mask:0xf
    v_mov_b32_dpp v117, v41 row_shl:8 row_mask:0xf bank_mask:0xf
    v_mfma_f32_16x16x32_bf16 v[76:79], a[52:55], v[112:115], v[76:79]
    v_mov_b32_dpp v118, v42 row_shl:8 row_mask:0xf bank_mask:0xf
    v_mov_b32_dpp v119, v43 row_shl:8 row_mask:0xf bank_mask:0xf
    s_nop 1
    v_mfma_f32_16x16x32_bf16 v[72:75], a[40:43], v[116:119], v[72:75]
    v_mov_b32_dpp v120, v40 row_shl:12 row_mask:0xf bank_mask:0xf
    v_mov_b32_dpp v121, v41 row_shl:12 row_mask:0xf bank_mask:0xf
    v_mfma_f32_16x16x32_bf16 v[76:79], a[56:59], v[116:119], v[76:79]
    v_mov_b32_dpp v122, v42 row_shl:12 row_mask:0xf bank_mask:0xf
    v_mov_b32_dpp v123, v43 row_shl:12 row_mask:0xf bank_mask:0xf
    s_nop 1
    v_mfma_f32_16x16x32_bf16 v[72:75], a[44:47], v[120:123], v[72:75]
    v_mfma_f32_16x16x32_bf16 v[76:79], a[60:63], v[120:123], v[76:79]
    s_cmp_eq_u32 s40, 0
    s_cselect_b32 s38, 0x500000, 0
    s_cselect_b32 s41, 0, 0x200000
    s_add_u32 s51, s51, s41
    s_lshr_b32 s54, s47, 1
    s_lshl2_add_u32 s54, s54, s44
    s_lshl_b32 s54, s54, 12
    s_and_b32 s3, s46, 15
    s_lshl4_add_u32 s54, s3, s54
    s_add_u32 s54, s54, s51
    s_add_u32 s54, s54, 0
    s_lshl_b32 s55, s44, 8
    s_lshl3_add_u32 s55, s46, s55
    s_add_u32 s55, s55, s51
    s_add_u32 s55, s55, 51200
    s_lshl_b32 s3, s44, 2
    v_add_u32 v5, s3, v30
    v_max3_f32 v104, v72, v73, v74
    v_max3_f32 v104, v104, v75, v76
    v_max3_f32 v104, v104, v77, v78
    v_max_f32 v105, v104, v79
    v_max_f32 v104, v104, v79
    s_nop 1
    v_permlane32_swap_b32 v104, v105
    v_max_f32 v106, v104, v105
    v_max_f32 v104, v104, v105
    s_nop 1
    v_permlane16_swap_b32 v104, v106
    v_max_f32 v104, v104, v106
    ds_write_b32 v20, v104
    v_pk_add_f32 v[72:73], v[72:73], v[104:105] op_sel_hi:[1,0] neg_lo:[0,1] neg_hi:[0,1]
    v_pk_add_f32 v[74:75], v[74:75], v[104:105] op_sel_hi:[1,0] neg_lo:[0,1] neg_hi:[0,1]
    v_pk_add_f32 v[76:77], v[76:77], v[104:105] op_sel_hi:[1,0] neg_lo:[0,1] neg_hi:[0,1]
    v_pk_add_f32 v[78:79], v[78:79], v[104:105] op_sel_hi:[1,0] neg_lo:[0,1] neg_hi:[0,1]
    v_exp_f32 v72, v72
    v_exp_f32 v73, v73
    v_exp_f32 v74, v74
    v_exp_f32 v75, v75
    v_exp_f32 v76, v76
    v_exp_f32 v77, v77
    v_exp_f32 v78, v78
    v_exp_f32 v79, v79
    v_cvt_pk_bf16_f32 v108, v72, v73
    v_cvt_pk_bf16_f32 v109, v74, v75
    v_cvt_pk_bf16_f32 v110, v76, v77
    v_cvt_pk_bf16_f32 v111, v78, v79
    v_mov_b32_dpp v88, v108 quad_perm:[0,1,2,3] row_mask:0xf bank_mask:0x1
    v_mov_b32_dpp v89, v109 quad_perm:[0,1,2,3] row_mask:0xf bank_mask:0x1
    v_mov_b32_dpp v90, v110 quad_perm:[0,1,2,3] row_mask:0xf bank_mask:0x1
    v_mov_b32_dpp v91, v111 quad_perm:[0,1,2,3] row_mask:0xf bank_mask:0x1
    v_mov_b32_dpp v92, v108 row_shr:4 row_mask:0xf bank_mask:0x2
    v_mov_b32_dpp v93, v109 row_shr:4 row_mask:0xf bank_mask:0x2
    v_mov_b32_dpp v94, v110 row_shr:4 row_mask:0xf bank_mask:0x2
    v_mov_b32_dpp v95, v111 row_shr:4 row_mask:0xf bank_mask:0x2
    v_mov_b32_dpp v96, v108 row_shr:8 row_mask:0xf bank_mask:0x4
    v_mov_b32_dpp v97, v109 row_shr:8 row_mask:0xf bank_mask:0x4
    v_mov_b32_dpp v98, v110 row_shr:8 row_mask:0xf bank_mask:0x4
    v_mov_b32_dpp v99, v111 row_shr:8 row_mask:0xf bank_mask:0x4
    v_mov_b32_dpp v100, v108 row_shr:12 row_mask:0xf bank_mask:0x8
    v_mov_b32_dpp v101, v109 row_shr:12 row_mask:0xf bank_mask:0x8
    v_mov_b32_dpp v102, v110 row_shr:12 row_mask:0xf bank_mask:0x8
    v_mov_b32_dpp v103, v111 row_shr:12 row_mask:0xf bank_mask:0x8
    s_waitcnt lgkmcnt(0)
    v_mfma_f32_16x16x32_bf16 v[120:123], v[36:39], v[88:91], 0
    s_branch L_over1
L_pad1:
    s_setpc_b64 s[12:13]
L_over1:
    s_barrier
    ds_read_b128 v[72:75], v30
    ds_read_b32 v76, v5
    ds_read_b64_tr_b16 a[64:65], v29 offset:0
    ds_read_b64_tr_b16 a[66:67], v29 offset:4096
    v_xor_b32 v4, 32, v29
    ds_read_b64_tr_b16 a[68:69], v4 offset:0
    ds_read_b64_tr_b16 a[70:71], v4 offset:4096
    v_xor_b32 v4, 64, v29
    ds_read_b64_tr_b16 a[72:73], v4 offset:0
    ds_read_b64_tr_b16 a[74:75], v4 offset:4096
    v_xor_b32 v4, 96, v29
    ds_read_b64_tr_b16 a[76:77], v4 offset:0
    ds_read_b64_tr_b16 a[78:79], v4 offset:4096
    v_xor_b32 v4, 128, v29
    ds_read_b64_tr_b16 a[80:81], v4 offset:0
    ds_read_b64_tr_b16 a[82:83], v4 offset:4096
    v_xor_b32 v4, 160, v29
    ds_read_b64_tr_b16 a[84:85], v4 offset:0
    ds_read_b64_tr_b16 a[86:87], v4 offset:4096
    v_xor_b32 v4, 192, v29
    ds_read_b64_tr_b16 a[88:89], v4 offset:0
    ds_read_b64_tr_b16 a[90:91], v4 offset:4096
    v_xor_b32 v4, 224, v29
    ds_read_b64_tr_b16 a[92:93], v4 offset:0
    ds_read_b64_tr_b16 a[94:95], v4 offset:4096
    s_waitcnt lgkmcnt(15)
    v_max3_f32 v78, v72, v73, v74
    v_max_f32 v78, v78, v75
    v_sub_f32 v78, v76, v78
    v_exp_f32 v78, v78
    s_waitcnt lgkmcnt(14)
    v_mfma_f32_16x16x32_bf16 v[112:115], a[64:67], v[88:91], 0
    s_waitcnt lgkmcnt(12)
    v_mfma_f32_16x16x32_bf16 v[112:115], a[68:71], v[92:95], v[112:115]
    s_waitcnt lgkmcnt(10)
    v_mfma_f32_16x16x32_bf16 v[112:115], a[72:75], v[96:99], v[112:115]
    s_waitcnt lgkmcnt(8)
    v_mfma_f32_16x16x32_bf16 v[112:115], a[76:79], v[100:103], v[112:115]
    s_waitcnt lgkmcnt(6)
    v_mfma_f32_16x16x32_bf16 v[116:119], a[80:83], v[88:91], 0
    s_waitcnt lgkmcnt(4)
    v_mfma_f32_16x16x32_bf16 v[116:119], a[84:87], v[92:95], v[116:119]
    s_waitcnt lgkmcnt(2)
    v_mfma_f32_16x16x32_bf16 v[116:119], a[88:91], v[96:99], v[116:119]
    s_waitcnt lgkmcnt(0)
    v_mfma_f32_16x16x32_bf16 v[116:119], a[92:95], v[100:103], v[116:119]
    v_mul_f32 v120, v120, v78
    ds_write_b32 v20, v120 offset:64
    v_pk_mul_f32 v[112:113], v[112:113], v[78:79] op_sel_hi:[1,0]
    v_pk_mul_f32 v[114:115], v[114:115], v[78:79] op_sel_hi:[1,0]
    ds_write_b128 v19, v[112:115] offset:0
    s_nop 2
    v_pk_mul_f32 v[116:117], v[116:117], v[78:79] op_sel_hi:[1,0]
    v_pk_mul_f32 v[118:119], v[118:119], v[78:79] op_sel_hi:[1,0]
    ds_write_b128 v19, v[116:119] offset:256
    s_waitcnt lgkmcnt(0)
    s_barrier
    ds_read_b64 v[112:113], v21 offset:0
    ds_read_b64 v[114:115], v21 offset:2112
    ds_read_b64 v[116:117], v21 offset:4224
    ds_read_b64 v[118:119], v21 offset:6336
    ds_read_b128 v[104:107], v22
    ds_read_b128 v[108:111], v22 offset:64
    s_waitcnt lgkmcnt(4)
    v_pk_add_f32 v[112:113], v[112:113], v[114:115]
    s_waitcnt lgkmcnt(2)
    v_pk_add_f32 v[116:117], v[116:117], v[118:119]
    v_pk_add_f32 v[112:113], v[112:113], v[116:117]
    v_cvt_pk_bf16_f32 v112, v112, v113
    buffer_store_dword v112, v23, s[36:39], s54 offen
    s_waitcnt lgkmcnt(0)
    v_pk_add_f32 v[108:109], v[108:109], v[110:111]
    v_max3_f32 v120, v104, v105, v106
    v_add_f32 v121, v108, v109
    v_max_f32 v120, v120, v107
    v_bfi_b32 v121, 1, s18, v121
    buffer_store_dwordx2 v[120:121], v9, s[36:39], s55 offen
    s_cmp_lg_u32 s40, 0
    s_cbranch_scc1 L_stub0
L_stub0_r:
    s_lshr_b32 s41, s60, 2
    s_add_u32 s41, s41, s51
    s_add_u32 s41, s41, 90112
    buffer_store_dwordx4 v[80:83], v18, s[36:39], s41 offen
    buffer_store_dwordx4 v[84:87], v18, s[36:39], s41 offen offset:512
    s_cmp_lg_u32 s40, 0
    s_cbranch_scc1 L_stub1
L_stub1_r:
    s_sub_u32 s42, s41, 57344
    v_lshrrev_b32 v6, 1, v2
    v_mul_u32_u24 v6, 480, v6
    v_add_u32 v18, v6, v18
    s_bitcmp1_b32 s46, 0
    s_cbranch_scc1 L_no_o0
    s_branch L_over2
L_pad2:
    s_setpc_b64 s[12:13]
L_over2:
    s_and_b32 s3, s46, 1
    s_lshl1_add_u32 s20, s44, s3
    s_lshl_b32 s20, s20, 7
    s_add_u32 s20, s20, s51
    s_add_u32 s20, s20, 51200
    s_lshl2_add_u32 s21, s3, s44
    s_lshl_b32 s21, s21, 12
    s_add_u32 s21, s21, s51
    s_add_u32 s21, s21, 0
    s_add_u32 s41, s21, 16384
    v_and_b32 v6, 8, v1
    v_lshl_add_u32 v6, v6, 4, v24
    v_lshrrev_b32 v4, 2, v1
    v_and_b32 v5, 3, v1
    v_lshlrev_b32 v5, 3, v5
    v_lshl_add_u32 v4, v4, 6, v5
    v_and_b32 v5, 1, v2
    v_lshl_add_u32 v4, v5, 5, v4
    v_add_u32 v4, s63, v4
    v_add_u32 v4, 65536, v4
    v_xor_b32 v5, 32, v4
L_op0:
    buffer_load_dword v107, v6, s[32:35], s20 offen sc1
    s_sub_i32 s49, s49, 1
    s_cmp_gt_i32 s49, 0
    s_cselect_b32 s50, -2, -1
    s_waitcnt vmcnt(0)
    v_cmp_lt_u32 vcc, s50, v107
    s_cbranch_vccnz L_op0
    buffer_load_dwordx4 v[40:43], v31, s[32:35], s21 offen sc1
    buffer_load_dwordx4 v[44:47], v32, s[32:35], s21 offen sc1
    buffer_load_dwordx4 v[48:51], v33, s[32:35], s21 offen sc1
    buffer_load_dwordx4 v[52:55], v34, s[32:35], s21 offen sc1
    buffer_load_dwordx4 v[56:59], v31, s[32:35], s41 offen sc1
    buffer_load_dwordx4 v[60:63], v32, s[32:35], s41 offen sc1
    buffer_load_dwordx4 v[64:67], v33, s[32:35], s41 offen sc1
    buffer_load_dwordx4 v[68:71], v34, s[32:35], s41 offen sc1
L_op0_w:
    v_mov_b32 v105, v107
    v_mov_b32 v106, v107
    s_nop 0
    v_mov_b32_dpp v105, v107 row_shr:4 row_mask:0xf bank_mask:0xa
    v_mov_b32_dpp v106, v107 row_shl:4 row_mask:0xf bank_mask:0x5
    s_nop 0
    v_max_f32_dpp v108, v105, v105 quad_perm:[1,0,3,2] row_mask:0xf bank_mask:0xf
    s_nop 1
    v_max_f32_dpp v127, v108, v108 quad_perm:[2,3,0,1] row_mask:0xf bank_mask:0xf
    v_max_f32_dpp v126, v108, v108 quad_perm:[2,3,0,1] row_mask:0xf bank_mask:0xf
    s_nop 1
    v_permlane16_swap_b32 v126, v127
    v_max_f32 v126, v126, v127
    v_sub_f32 v104, v105, v126
    v_exp_f32 v104, v104
    s_nop 0
    v_mul_f32 v125, v104, v106
    s_nop 1
    v_add_f32_dpp v125, v125, v125 quad_perm:[1,0,3,2] row_mask:0xf bank_mask:0xf
    s_nop 1
    v_add_f32_dpp v111, v125, v125 quad_perm:[2,3,0,1] row_mask:0xf bank_mask:0xf
    v_add_f32_dpp v110, v125, v125 quad_perm:[2,3,0,1] row_mask:0xf bank_mask:0xf
    s_nop 1
    v_permlane16_swap_b32 v110, v111
    v_add_f32 v110, v110, v111
    v_rcp_f32 v110, v110
    s_nop 0
    v_mul_f32 v124, v104, v110
    v_and_b32 v112, 1, v107
    v_cmp_eq_u32 vcc, 1, v112
    s_mov_b32 s3, 0xf0f0f0f0
    s_and_b32 vcc_lo, vcc_lo, s3
    s_and_b32 vcc_hi, vcc_hi, s3
    s_bcnt1_i32_b64 s22, vcc
    s_lshl_b32 s3, s44, 2
    s_add_u32 s3, s3, 154160
    v_mov_b32 v112, s3
    v_mov_b32 v113, s22
    ds_write_b32 v112, v113
    v_mov_b32 v105, v124
    v_mov_b32 v106, v124
    s_nop 0
    v_mov_b32_dpp v105, v124 row_shr:8 row_mask:0xf bank_mask:0xc
    v_mov_b32_dpp v106, v124 row_shl:8 row_mask:0xf bank_mask:0x3
    s_nop 0
    v_mov_b32_dpp v116, v105 quad_perm:[0,0,0,0] row_mask:0xf bank_mask:0xf
    v_mov_b32_dpp v117, v105 quad_perm:[1,1,1,1] row_mask:0xf bank_mask:0xf
    v_mov_b32_dpp v118, v105 quad_perm:[2,2,2,2] row_mask:0xf bank_mask:0xf
    v_mov_b32_dpp v119, v105 quad_perm:[3,3,3,3] row_mask:0xf bank_mask:0xf
    v_mov_b32_dpp v120, v106 quad_perm:[0,0,0,0] row_mask:0xf bank_mask:0xf
    v_mov_b32_dpp v121, v106 quad_perm:[1,1,1,1] row_mask:0xf bank_mask:0xf
    v_mov_b32_dpp v122, v106 quad_perm:[2,2,2,2] row_mask:0xf bank_mask:0xf
    v_mov_b32_dpp v123, v106 quad_perm:[3,3,3,3] row_mask:0xf bank_mask:0xf
    s_waitcnt lgkmcnt(0)
    s_barrier
    ds_read_b64_tr_b16 a[96:97], v4 offset:0
    ds_read_b64_tr_b16 a[98:99], v4 offset:1024
    ds_read_b64_tr_b16 a[112:113], v5 offset:0
    ds_read_b64_tr_b16 a[114:115], v5 offset:1024
    ds_read_b64_tr_b16 a[100:101], v4 offset:2048
    ds_read_b64_tr_b16 a[102:103], v4 offset:3072
    ds_read_b64_tr_b16 a[116:117], v5 offset:2048
    ds_read_b64_tr_b16 a[118:119], v5 offset:3072
    ds_read_b64_tr_b16 a[104:105], v4 offset:4096
    ds_read_b64_tr_b16 a[106:107], v4 offset:5120
    ds_read_b64_tr_b16 a[120:121], v5 offset:4096
    ds_read_b64_tr_b16 a[122:123], v5 offset:5120
    ds_read_b64_tr_b16 a[108:109], v4 offset:6144
    ds_read_b64_tr_b16 a[110:111], v4 offset:7168
    ds_read_b64_tr_b16 a[124:125], v5 offset:6144
    ds_read_b64_tr_b16 a[126:127], v5 offset:7168
    s_branch L_op0_m
L_pad3:
    s_setpc_b64 s[12:13]
L_op0_d:
    buffer_load_dwordx4 v[40:43], v31, s[32:35], s21 offen sc1
    buffer_load_dwordx4 v[44:47], v32, s[32:35], s21 offen sc1
    buffer_load_dwordx4 v[48:51], v33, s[32:35], s21 offen sc1
    buffer_load_dwordx4 v[52:55], v34, s[32:35], s21 offen sc1
    buffer_load_dwordx4 v[56:59], v31, s[32:35], s41 offen sc1
    buffer_load_dwordx4 v[60:63], v32, s[32:35], s41 offen sc1
    buffer_load_dwordx4 v[64:67], v33, s[32:35], s41 offen sc1
    buffer_load_dwordx4 v[68:71], v34, s[32:35], s41 offen sc1
    s_sub_i32 s49, s49, 1
    s_cmp_gt_i32 s49, 0
    s_cselect_b32 s50, -2, -1
L_op0_m:
    s_waitcnt vmcnt(7) lgkmcnt(12)
    v_mfma_f32_16x16x32_bf16 v[72:75], v[40:43], a[96:99], 0
    v_max_u32 v4, v40, v43
    v_mfma_f32_16x16x32_bf16 v[76:79], v[40:43], a[112:115], 0
    s_waitcnt vmcnt(6) lgkmcnt(8)
    v_mfma_f32_16x16x32_bf16 v[72:75], v[44:47], a[100:103], v[72:75]
    v_max3_u32 v4, v4, v44, v47
    v_mfma_f32_16x16x32_bf16 v[76:79], v[44:47], a[116:119], v[76:79]
    s_waitcnt vmcnt(5) lgkmcnt(4)
    v_mfma_f32_16x16x32_bf16 v[72:75], v[48:51], a[104:107], v[72:75]
    v_max3_u32 v4, v4, v48, v51
    v_mfma_f32_16x16x32_bf16 v[76:79], v[48:51], a[120:123], v[76:79]
    s_waitcnt vmcnt(4) lgkmcnt(0)
    v_mfma_f32_16x16x32_bf16 v[72:75], v[52:55], a[108:111], v[72:75]
    v_max3_u32 v4, v4, v52, v55
    v_mfma_f32_16x16x32_bf16 v[76:79], v[52:55], a[124:127], v[76:79]
    s_waitcnt vmcnt(3)
    v_mfma_f32_16x16x32_bf16 v[80:83], v[56:59], a[96:99], 0
    v_max3_u32 v4, v4, v56, v59
    v_mfma_f32_16x16x32_bf16 v[84:87], v[56:59], a[112:115], 0
    s_waitcnt vmcnt(2)
    v_mfma_f32_16x16x32_bf16 v[80:83], v[60:63], a[100:103], v[80:83]
    v_max3_u32 v4, v4, v60, v63
    v_mfma_f32_16x16x32_bf16 v[84:87], v[60:63], a[116:119], v[84:87]
    s_waitcnt vmcnt(1)
    v_mfma_f32_16x16x32_bf16 v[80:83], v[64:67], a[104:107], v[80:83]
    v_max3_u32 v4, v4, v64, v67
    v_pk_mul_f32 v[112:113], v[116:117], v[72:73]
    v_mfma_f32_16x16x32_bf16 v[84:87], v[64:67], a[120:123], v[84:87]
    v_pk_fma_f32 v[112:113], v[118:119], v[74:75], v[112:113]
    v_pk_mul_f32 v[114:115], v[116:117], v[76:77]
    s_waitcnt vmcnt(0)
    v_mfma_f32_16x16x32_bf16 v[80:83], v[68:71], a[108:111], v[80:83]
    v_max3_u32 v4, v4, v68, v71
    v_pk_fma_f32 v[114:115], v[118:119], v[78:79], v[114:115]
    v_mfma_f32_16x16x32_bf16 v[84:87], v[68:71], a[124:127], v[84:87]
    v_add_f32 v112, v112, v113
    v_add_f32 v113, v114, v115
    v_cmp_lt_u32 vcc, s50, v4
    s_nop 1
    v_permlane16_swap_b32 v112, v113
    v_add_f32 v112, v112, v113
    ds_write_b32 v25, v112 offset:0
    s_cbranch_vccnz L_op0_d
    v_pk_mul_f32 v[124:125], v[120:121], v[80:81]
    v_pk_fma_f32 v[124:125], v[122:123], v[82:83], v[124:125]
    v_pk_mul_f32 v[126:127], v[120:121], v[84:85]
    v_pk_fma_f32 v[126:127], v[122:123], v[86:87], v[126:127]
    v_add_f32 v124, v124, v125
    v_add_f32 v125, v126, v127
    s_nop 1
    v_permlane16_swap_b32 v124, v125
    v_add_f32 v124, v124, v125
    ds_write_b32 v25, v124 offset:1024
    s_waitcnt lgkmcnt(0)
    s_barrier
L_no_o0:
    s_lshl2_add_u32 s3, s53, s44
    s_lshl3_add_u32 s54, s53, s44
    s_lshl_b32 s54, s54, 11
    s_add_u32 s54, s54, 0x160000
    s_add_u32 s55, s60, s51
    s_add_u32 s55, s55, 114688
    s_add_u32 s62, s56, 1
    s_bitcmp1_b32 s46, 0
    s_cbranch_scc1 L_p1u0_odd
    s_barrier
    v_mov_b32 v4, 154148
    ds_read_b32 v4, v4
    s_waitcnt lgkmcnt(0)
    v_readfirstlane_b32 s43, v4
    s_nop 0
    s_add_u32 s54, s54, s43
    s_nop 15
    s_nop 15
    s_nop 15
    s_nop 15
    s_nop 15
    s_nop 15
    s_nop 13
    s_branch L_p1u0_p
L_pad4:
    s_setpc_b64 s[12:13]
L_p1u0_odd:
    v_subrev_u32 v4, s63, v29
    s_lshl_b32 s41, s44, 5
    v_xor_b32 v4, s41, v4
    v_add_u32 v4, 65536, v4
    v_xor_b32 v5, 128, v4
    s_barrier
    ds_read_b64_tr_b16 a[96:97], v4 offset:0
    ds_read_b64_tr_b16 a[98:99], v4 offset:4096
    ds_read_b64_tr_b16 a[100:101], v4 offset:8192
    ds_read_b64_tr_b16 a[102:103], v4 offset:12288
    ds_read_b64_tr_b16 a[104:105], v4 offset:16384
    ds_read_b64_tr_b16 a[106:107], v4 offset:20480
    ds_read_b64_tr_b16 a[108:109], v4 offset:24576
    ds_read_b64_tr_b16 a[110:111], v4 offset:28672
    ds_read_b64_tr_b16 a[16:17], v5 offset:0
    ds_read_b64_tr_b16 a[18:19], v5 offset:4096
    ds_read_b64_tr_b16 a[20:21], v5 offset:8192
    ds_read_b64_tr_b16 a[22:23], v5 offset:12288
    ds_read_b64_tr_b16 a[24:25], v5 offset:16384
    ds_read_b64_tr_b16 a[26:27], v5 offset:20480
    ds_read_b64_tr_b16 a[28:29], v5 offset:24576
    ds_read_b64_tr_b16 a[30:31], v5 offset:28672
    s_sub_u32 s41, s42, 4096
    s_waitcnt lgkmcnt(0)
    v_mfma_f32_16x16x32_bf16 v[72:75], a[96:99], v[36:39], 0
    v_mfma_f32_16x16x32_bf16 v[72:75], a[100:103], v[36:39], v[72:75]
    v_mfma_f32_16x16x32_bf16 v[76:79], a[104:107], v[36:39], 0
    v_mfma_f32_16x16x32_bf16 v[76:79], a[108:111], v[36:39], v[76:79]
    v_mfma_f32_16x16x32_bf16 v[80:83], a[16:19], v[36:39], 0
    v_mfma_f32_16x16x32_bf16 v[80:83], a[20:23], v[36:39], v[80:83]
    v_mfma_f32_16x16x32_bf16 v[84:87], a[24:27], v[36:39], 0
    v_mfma_f32_16x16x32_bf16 v[84:87], a[28:31], v[36:39], v[84:87]
    s_nop 7
    buffer_store_dwordx4 v[72:75], v18, s[36:39], s41 offen
    buffer_store_dwordx4 v[76:79], v18, s[36:39], s41 offen offset:32
    buffer_store_dwordx4 v[80:83], v18, s[36:39], s42 offen
    buffer_store_dwordx4 v[84:87], v18, s[36:39], s42 offen offset:32
    s_cmp_lg_u32 s40, 0
    s_cbranch_scc1 L_stub2
L_stub2_r:
    s_barrier
    v_mov_b32 v4, 154148
    ds_read_b32 v4, v4
    s_waitcnt lgkmcnt(0)
    v_readfirstlane_b32 s43, v4
    s_nop 0
    s_add_u32 s54, s54, s43
    s_nop 0
L_p1u0_p:
    buffer_load_dwordx4 v[40:43], v8, s[32:35], s54 offen sc1
    buffer_load_dwordx4 v[44:47], v8, s[32:35], s54 offen offset:1024 sc1
    s_branch L_p1u0_0
L_pad5:
    s_setpc_b64 s[12:13]
L_p1u0_f0:
    buffer_load_dwordx4 v[40:43], v8, s[32:35], s54 offen sc1
    buffer_load_dwordx4 v[44:47], v8, s[32:35], s54 offen offset:1024 sc1
    s_sub_i32 s49, s49, 1
    s_cmp_gt_i32 s49, 0
    s_cselect_b32 s58, 0, -1
L_p1u0_0:
    s_waitcnt vmcnt(0)
    v_pk_add_f32 v[104:105], v[40:41], v[44:45]
    v_pk_add_f32 v[106:107], v[42:43], v[46:47]
    v_bitop3_b32 v4, v40, v44, s56 bitop3:0x7e
    v_and_b32 v4, 0xff, v4
    v_permlane32_swap_b32 v104, v106
    v_permlane32_swap_b32 v105, v107
    v_pk_add_f32 v[104:105], v[104:105], v[106:107]
    v_cmp_lt_u32 vcc, s58, v4
    s_cbranch_vccnz L_p1u0_f0
    v_permlane16_swap_b32 v104, v105
    v_add_f32 v104, v104, v105
    v_cvt_pk_bf16_f32 v104, v104, v104
    v_and_b32 v104, 0xffff0000, v104
    v_add_f32 v104, v104, v26
    v_cvt_pk_bf16_f32 v104, v104, v104
    ds_write_b16 v14, v104 offset:1536
L_p1u0_done:
    v_and_b32 v26, 0xffff0000, v104
    s_cmp_eq_u32 s45, 7
    s_cbranch_scc1 L_p1u0_skip
    s_waitcnt lgkmcnt(0)
    s_barrier
    s_bitcmp0_b32 s46, 0
    s_cbranch_scc1 L_p1u0_skip
    ds_read_b128 v[108:111], v12 offset:1536
    ds_read_b128 v[112:115], v12 offset:1792
    ds_read_b128 v[116:119], v15 offset:1536
    ds_read_b128 v[120:123], v15 offset:1792
    s_sub_u32 s41, s55, 16384
    s_waitcnt lgkmcnt(3)
    v_mfma_f32_16x16x32_bf16 v[72:75], v[108:111], a[16:19], 0
    s_waitcnt lgkmcnt(2)
    v_mfma_f32_16x16x32_bf16 v[72:75], v[112:115], a[20:23], v[72:75]
    s_waitcnt lgkmcnt(1)
    v_mfma_f32_16x16x32_bf16 v[72:75], v[116:119], a[24:27], v[72:75]
    s_waitcnt lgkmcnt(0)
    v_mfma_f32_16x16x32_bf16 v[72:75], v[120:123], a[28:31], v[72:75]
    v_mfma_f32_16x16x32_bf16 v[76:79], v[108:111], a[96:99], 0
    v_mfma_f32_16x16x32_bf16 v[76:79], v[112:115], a[100:103], v[76:79]
    v_mfma_f32_16x16x32_bf16 v[76:79], v[116:119], a[104:107], v[76:79]
    v_mfma_f32_16x16x32_bf16 v[76:79], v[120:123], a[108:111], v[76:79]
    s_nop 3
    v_bfi_b32 v72, v10, s62, v72
    buffer_store_dwordx4 v[72:75], v17, s[36:39], s55 offen
    s_nop 1
    v_bfi_b32 v76, v10, s62, v76
    buffer_store_dwordx4 v[76:79], v17, s[36:39], s41 offen
    s_cmp_lg_u32 s40, 0
    s_cbranch_scc1 L_stub3
L_stub3_r:
L_p1u0_skip:
    s_lshl2_add_u32 s3, s53, s44
    s_lshl3_add_u32 s54, s53, s44
    s_lshl_b32 s54, s54, 11
    s_add_u32 s54, s54, 0x180000
    s_add_u32 s55, s60, s51
    s_add_u32 s55, s55, 114688
    s_add_u32 s62, s56, 2
    s_add_u32 s54, s54, s43
    s_cmp_lg_u32 s45, 7
    s_cbranch_scc1 L_p1q1_b
    s_sleep 34
    s_branch L_p1q1_p
.p2align 12
L_pad6:
    s_setpc_b64 s[12:13]
L_p1q1_b:
    s_barrier
    s_nop 15
    s_nop 15
    s_nop 15
    s_nop 15
    s_nop 15
    s_nop 15
    s_nop 15
    s_nop 15
    s_nop 1
L_p1q1_p:
    buffer_load_dwordx4 v[40:43], v8, s[32:35], s54 offen sc1
    buffer_load_dwordx4 v[44:47], v8, s[32:35], s54 offen offset:1024 sc1
    s_branch L_p1q1_0
L_p1q1_f0:
    buffer_load_dwordx4 v[40:43], v8, s[32:35], s54 offen sc1
    buffer_load_dwordx4 v[44:47], v8, s[32:35], s54 offen offset:1024 sc1
    s_sub_i32 s49, s49, 1
    s_cmp_gt_i32 s49, 0
    s_cselect_b32 s58, 0, -1
L_p1q1_0:
    s_waitcnt vmcnt(0)
    v_pk_add_f32 v[104:105], v[40:41], v[44:45]
    v_pk_add_f32 v[106:107], v[42:43], v[46:47]
    v_bitop3_b32 v4, v40, v44, s56 bitop3:0x7e
    v_and_b32 v4, 0xff, v4
    v_permlane32_swap_b32 v104, v106
    v_permlane32_swap_b32 v105, v107
    v_pk_add_f32 v[104:105], v[104:105], v[106:107]
    v_cmp_lt_u32 vcc, s58, v4
    s_cbranch_vccnz L_p1q1_f0
    v_permlane16_swap_b32 v104, v105
    v_add_f32 v104, v104, v105
    v_cvt_pk_bf16_f32 v104, v104, v104
    v_and_b32 v104, 0xffff0000, v104
    v_add_f32 v104, v104, v26
    v_cvt_pk_bf16_f32 v104, v104, v104
    ds_write_b16 v14, v104 offset:0
L_p1q1_done:
    v_and_b32 v26, 0xffff0000, v104
    s_waitcnt lgkmcnt(0)
    s_barrier
    ds_read_b128 v[108:111], v12 offset:0
    ds_read_b128 v[112:115], v12 offset:256
    ds_read_b128 v[116:119], v15 offset:0
    ds_read_b128 v[120:123], v15 offset:256
    s_waitcnt lgkmcnt(3)
    v_mfma_f32_16x16x32_bf16 v[72:75], v[108:111], a[0:3], 0
    s_waitcnt lgkmcnt(2)
    v_mfma_f32_16x16x32_bf16 v[72:75], v[112:115], a[4:7], v[72:75]
    s_waitcnt lgkmcnt(1)
    v_mfma_f32_16x16x32_bf16 v[72:75], v[116:119], a[8:11], v[72:75]
    s_waitcnt lgkmcnt(0)
    v_mfma_f32_16x16x32_bf16 v[72:75], v[120:123], a[12:15], v[72:75]
    s_nop 7
    v_bfi_b32 v72, v10, s62, v72
    buffer_store_dwordx4 v[72:75], v16, s[36:39], s55 offen
    s_cmp_lg_u32 s40, 0
    s_cbranch_scc1 L_stub4
L_stub4_r:
    s_bitcmp0_b32 s46, 0
    s_cbranch_scc1 L_have_wo
    v_lshrrev_b32 v4, 2, v1
    v_and_b32 v5, 3, v1
    v_lshlrev_b32 v5, 3, v5
    v_lshl_add_u32 v4, v4, 6, v5
    v_and_b32 v5, 1, v2
    v_lshl_add_u32 v4, v5, 5, v4
    v_add_u32 v4, s63, v4
    v_add_u32 v4, 65536, v4
    v_xor_b32 v5, 32, v4
    ds_read_b64_tr_b16 a[96:97], v4 offset:0
    ds_read_b64_tr_b16 a[98:99], v4 offset:1024
    ds_read_b64_tr_b16 a[112:113], v5 offset:0
    ds_read_b64_tr_b16 a[114:115], v5 offset:1024
    ds_read_b64_tr_b16 a[100:101], v4 offset:2048
    ds_read_b64_tr_b16 a[102:103], v4 offset:3072
    ds_read_b64_tr_b16 a[116:117], v5 offset:2048
    ds_read_b64_tr_b16 a[118:119], v5 offset:3072
    ds_read_b64_tr_b16 a[104:105], v4 offset:4096
    ds_read_b64_tr_b16 a[106:107], v4 offset:5120
    ds_read_b64_tr_b16 a[120:121], v5 offset:4096
    ds_read_b64_tr_b16 a[122:123], v5 offset:5120
    ds_read_b64_tr_b16 a[108:109], v4 offset:6144
    ds_read_b64_tr_b16 a[110:111], v4 offset:7168
    ds_read_b64_tr_b16 a[124:125], v5 offset:6144
    ds_read_b64_tr_b16 a[126:127], v5 offset:7168
    s_branch L_have_wu
L_pad7:
    s_setpc_b64 s[12:13]
L_have_wo:
    ds_read_b64_tr_b16 a[16:17], v28 offset:0
    ds_read_b64_tr_b16 a[18:19], v28 offset:2048
    ds_read_b64_tr_b16 a[20:21], v28 offset:4096
    ds_read_b64_tr_b16 a[22:23], v28 offset:6144
    ds_read_b64_tr_b16 a[24:25], v28 offset:8192
    ds_read_b64_tr_b16 a[26:27], v28 offset:10240
    ds_read_b64_tr_b16 a[28:29], v28 offset:12288
    ds_read_b64_tr_b16 a[30:31], v28 offset:14336
L_have_wu:
    s_and_b32 s3, s46, 1
    s_lshl1_add_u32 s20, s44, s3
    s_lshl_b32 s20, s20, 7
    s_add_u32 s20, s20, s51
    s_add_u32 s20, s20, 108544
    s_lshl2_add_u32 s21, s3, s44
    s_lshl_b32 s21, s21, 12
    s_add_u32 s21, s21, s51
    s_add_u32 s21, s21, 57344
    s_lshl_b32 s3, s44, 6
    s_add_u32 s3, s3, 154368
    v_lshl_add_u32 v24, v2, 4, s3
    s_lshr_b32 s54, s47, 1
    s_lshl2_add_u32 s54, s54, s44
    s_lshl_b32 s54, s54, 12
    s_and_b32 s3, s46, 15
    s_lshl4_add_u32 s54, s3, s54
    s_add_u32 s54, s54, s51
    s_add_u32 s54, s54, 57344
    s_lshl_b32 s55, s44, 8
    s_lshl3_add_u32 s55, s46, s55
    s_add_u32 s55, s55, s51
    s_add_u32 s55, s55, 108544
    s_lshl_b32 s3, s44, 2
    v_add_u32 v5, s3, v30
    s_lshl_b32 s41, s47, 10
    s_add_u32 s41, s41, s51
    s_add_u32 s41, s41, 109568
    s_barrier
    buffer_load_dwordx4 v[40:43], v8, s[32:35], s41 offen sc1
    s_nop 15
    s_nop 3
    buffer_load_dwordx4 v[44:47], v8, s[32:35], s41 offen sc1
    s_nop 15
    s_nop 3
    buffer_load_dwordx4 v[48:51], v8, s[32:35], s41 offen sc1
    s_branch L_sp1_0
L_sp1_f2:
    buffer_load_dwordx4 v[48:51], v8, s[32:35], s41 offen sc1
    s_sub_i32 s49, s49, 1
    s_cmp_gt_i32 s49, 0
    s_cselect_b32 s50, -2, -1
L_sp1_0:
    s_waitcnt vmcnt(2)
    v_mfma_f32_16x16x32_bf16 v[72:75], a[32:35], v[40:43], 0
    v_max3_u32 v4, v40, v41, v42
    v_max_u32 v4, v4, v43
    v_cmp_lt_u32 vcc, s50, v4
    s_cbranch_vccnz L_sp1_f0
    v_mov_b32_dpp v112, v40 row_shl:4 row_mask:0xf bank_mask:0xf
    v_mov_b32_dpp v113, v41 row_shl:4 row_mask:0xf bank_mask:0xf
    v_mfma_f32_16x16x32_bf16 v[76:79], a[48:51], v[40:43], 0
    v_mov_b32_dpp v114, v42 row_shl:4 row_mask:0xf bank_mask:0xf
    v_mov_b32_dpp v115, v43 row_shl:4 row_mask:0xf bank_mask:0xf
    s_nop 1
    v_mfma_f32_16x16x32_bf16 v[72:75], a[36:39], v[112:115], v[72:75]
    v_mov_b32_dpp v116, v40 row_shl:8 row_mask:0xf bank_mask:0xf
    v_mov_b32_dpp v117, v41 row_shl:8 row_mask:0xf bank_mask:0xf
    v_mfma_f32_16x16x32_bf16 v[76:79], a[52:55], v[112:115], v[76:79]
    v_mov_b32_dpp v118, v42 row_shl:8 row_mask:0xf bank_mask:0xf
    v_mov_b32_dpp v119, v43 row_shl:8 row_mask:0xf bank_mask:0xf
    s_nop 1
    v_mfma_f32_16x16x32_bf16 v[72:75], a[40:43], v[116:119], v[72:75]
    v_mov_b32_dpp v120, v40 row_shl:12 row_mask:0xf bank_mask:0xf
    v_mov_b32_dpp v121, v41 row_shl:12 row_mask:0xf bank_mask:0xf
    v_mfma_f32_16x16x32_bf16 v[76:79], a[56:59], v[116:119], v[76:79]
    v_mov_b32_dpp v122, v42 row_shl:12 row_mask:0xf bank_mask:0xf
    v_mov_b32_dpp v123, v43 row_shl:12 row_mask:0xf bank_mask:0xf
    s_branch L_sp1_done
L_pad8:
    s_setpc_b64 s[12:13]
L_sp1_f0:
    buffer_load_dwordx4 v[40:43], v8, s[32:35], s41 offen sc1
L_sp1_1:
    s_waitcnt vmcnt(2)
    v_mfma_f32_16x16x32_bf16 v[72:75], a[32:35], v[44:47], 0
    v_max3_u32 v4, v44, v45, v46
    v_max_u32 v4, v4, v47
    v_cmp_lt_u32 vcc, s50, v4
    s_cbranch_vccnz L_sp1_f1
    v_mov_b32_dpp v112, v44 row_shl:4 row_mask:0xf bank_mask:0xf
    v_mov_b32_dpp v113, v45 row_shl:4 row_mask:0xf bank_mask:0xf
    v_mfma_f32_16x16x32_bf16 v[76:79], a[48:51], v[44:47], 0
    v_mov_b32_dpp v114, v46 row_shl:4 row_mask:0xf bank_mask:0xf
    v_mov_b32_dpp v115, v47 row_shl:4 row_mask:0xf bank_mask:0xf
    s_nop 1
    v_mfma_f32_16x16x32_bf16 v[72:75], a[36:39], v[112:115], v[72:75]
    v_mov_b32_dpp v116, v44 row_shl:8 row_mask:0xf bank_mask:0xf
    v_mov_b32_dpp v117, v45 row_shl:8 row_mask:0xf bank_mask:0xf
    v_mfma_f32_16x16x32_bf16 v[76:79], a[52:55], v[112:115], v[76:79]
    v_mov_b32_dpp v118, v46 row_shl:8 row_mask:0xf bank_mask:0xf
    v_mov_b32_dpp v119, v47 row_shl:8 row_mask:0xf bank_mask:0xf
    s_nop 1
    v_mfma_f32_16x16x32_bf16 v[72:75], a[40:43], v[116:119], v[72:75]
    v_mov_b32_dpp v120, v44 row_shl:12 row_mask:0xf bank_mask:0xf
    v_mov_b32_dpp v121, v45 row_shl:12 row_mask:0xf bank_mask:0xf
    v_mfma_f32_16x16x32_bf16 v[76:79], a[56:59], v[116:119], v[76:79]
    v_mov_b32_dpp v122, v46 row_shl:12 row_mask:0xf bank_mask:0xf
    v_mov_b32_dpp v123, v47 row_shl:12 row_mask:0xf bank_mask:0xf
    s_branch L_sp1_done
L_pad9:
    s_setpc_b64 s[12:13]
L_sp1_f1:
    buffer_load_dwordx4 v[44:47], v8, s[32:35], s41 offen sc1
L_sp1_2:
    s_waitcnt vmcnt(2)
    v_mfma_f32_16x16x32_bf16 v[72:75], a[32:35], v[48:51], 0
    v_max3_u32 v4, v48, v49, v50
    v_max_u32 v4, v4, v51
    v_cmp_lt_u32 vcc, s50, v4
    s_cbranch_vccnz L_sp1_f2
    v_mov_b32_dpp v112, v48 row_shl:4 row_mask:0xf bank_mask:0xf
    v_mov_b32_dpp v113, v49 row_shl:4 row_mask:0xf bank_mask:0xf
    v_mfma_f32_16x16x32_bf16 v[76:79], a[48:51], v[48:51], 0
    v_mov_b32_dpp v114, v50 row_shl:4 row_mask:0xf bank_mask:0xf
    v_mov_b32_dpp v115, v51 row_shl:4 row_mask:0xf bank_mask:0xf
    s_nop 1
    v_mfma_f32_16x16x32_bf16 v[72:75], a[36:39], v[112:115], v[72:75]
    v_mov_b32_dpp v116, v48 row_shl:8 row_mask:0xf bank_mask:0xf
    v_mov_b32_dpp v117, v49 row_shl:8 row_mask:0xf bank_mask:0xf
    v_mfma_f32_16x16x32_bf16 v[76:79], a[52:55], v[112:115], v[76:79]
    v_mov_b32_dpp v118, v50 row_shl:8 row_mask:0xf bank_mask:0xf
    v_mov_b32_dpp v119, v51 row_shl:8 row_mask:0xf bank_mask:0xf
    s_nop 1
    v_mfma_f32_16x16x32_bf16 v[72:75], a[40:43], v[116:119], v[72:75]
    v_mov_b32_dpp v120, v48 row_shl:12 row_mask:0xf bank_mask:0xf
    v_mov_b32_dpp v121, v49 row_shl:12 row_mask:0xf bank_mask:0xf
    v_mfma_f32_16x16x32_bf16 v[76:79], a[56:59], v[116:119], v[76:79]
    v_mov_b32_dpp v122, v50 row_shl:12 row_mask:0xf bank_mask:0xf
    v_mov_b32_dpp v123, v51 row_shl:12 row_mask:0xf bank_mask:0xf
L_sp1_done:
    s_nop 1
    v_mfma_f32_16x16x32_bf16 v[72:75], a[44:47], v[120:123], v[72:75]
    v_mfma_f32_16x16x32_bf16 v[76:79], a[60:63], v[120:123], v[76:79]
    v_mov_b32 v4, v4
    v_mov_b32 v4, v4
    v_mov_b32 v4, v4
    v_mov_b32 v4, v4
    v_mov_b32 v4, v4
    v_mov_b32 v4, v4
    v_mov_b32 v4, v4
    v_max3_f32 v104, v72, v73, v74
    v_max3_f32 v104, v104, v75, v76
    v_max3_f32 v104, v104, v77, v78
    v_max_f32 v105, v104, v79
    v_max_f32 v104, v104, v79
    s_nop 1
    v_permlane32_swap_b32 v104, v105
    v_max_f32 v106, v104, v105
    v_max_f32 v104, v104, v105
    s_nop 1
    v_permlane16_swap_b32 v104, v106
    v_max_f32 v104, v104, v106
    ds_write_b32 v20, v104
    v_pk_add_f32 v[72:73], v[72:73], v[104:105] op_sel_hi:[1,0] neg_lo:[0,1] neg_hi:[0,1]
    v_pk_add_f32 v[74:75], v[74:75], v[104:105] op_sel_hi:[1,0] neg_lo:[0,1] neg_hi:[0,1]
    v_pk_add_f32 v[76:77], v[76:77], v[104:105] op_sel_hi:[1,0] neg_lo:[0,1] neg_hi:[0,1]
    v_pk_add_f32 v[78:79], v[78:79], v[104:105] op_sel_hi:[1,0] neg_lo:[0,1] neg_hi:[0,1]
    v_exp_f32 v72, v72
    v_exp_f32 v73, v73
    v_exp_f32 v74, v74
    v_exp_f32 v75, v75
    v_exp_f32 v76, v76
    v_exp_f32 v77, v77
    v_exp_f32 v78, v78
    v_exp_f32 v79, v79
    v_cvt_pk_bf16_f32 v108, v72, v73
    v_cvt_pk_bf16_f32 v109, v74, v75
    v_cvt_pk_bf16_f32 v110, v76, v77
    v_cvt_pk_bf16_f32 v111, v78, v79
    v_mov_b32_dpp v88, v108 quad_perm:[0,1,2,3] row_mask:0xf bank_mask:0x1
    v_mov_b32_dpp v89, v109 quad_perm:[0,1,2,3] row_mask:0xf bank_mask:0x1
    v_mov_b32_dpp v90, v110 quad_perm:[0,1,2,3] row_mask:0xf bank_mask:0x1
    v_mov_b32_dpp v91, v111 quad_perm:[0,1,2,3] row_mask:0xf bank_mask:0x1
    v_mov_b32_dpp v92, v108 row_shr:4 row_mask:0xf bank_mask:0x2
    v_mov_b32_dpp v93, v109 row_shr:4 row_mask:0xf bank_mask:0x2
    v_mfma_f32_16x16x32_bf16 v[120:123], v[36:39], v[88:91], 0
    s_waitcnt lgkmcnt(0)
    s_barrier
    v_mfma_f32_16x16x32_bf16 v[112:115], a[64:67], v[88:91], 0
    ds_read_b128 v[72:75], v30
    ds_read_b32 v76, v5
    v_mov_b32_dpp v94, v110 row_shr:4 row_mask:0xf bank_mask:0x2
    v_mov_b32_dpp v95, v111 row_shr:4 row_mask:0xf bank_mask:0x2
    v_mfma_f32_16x16x32_bf16 v[116:119], a[80:83], v[88:91], 0
    v_mov_b32_dpp v96, v108 row_shr:8 row_mask:0xf bank_mask:0x4
    v_mov_b32_dpp v97, v109 row_shr:8 row_mask:0xf bank_mask:0x4
    v_mfma_f32_16x16x32_bf16 v[112:115], a[68:71], v[92:95], v[112:115]
    v_mov_b32_dpp v98, v110 row_shr:8 row_mask:0xf bank_mask:0x4
    v_mov_b32_dpp v99, v111 row_shr:8 row_mask:0xf bank_mask:0x4
    v_mfma_f32_16x16x32_bf16 v[116:119], a[84:87], v[92:95], v[116:119]
    v_mov_b32_dpp v100, v108 row_shr:12 row_mask:0xf bank_mask:0x8
    v_mov_b32_dpp v101, v109 row_shr:12 row_mask:0xf bank_mask:0x8
    v_mfma_f32_16x16x32_bf16 v[112:115], a[72:75], v[96:99], v[112:115]
    v_mov_b32_dpp v102, v110 row_shr:12 row_mask:0xf bank_mask:0x8
    v_mov_b32_dpp v103, v111 row_shr:12 row_mask:0xf bank_mask:0x8
    v_mfma_f32_16x16x32_bf16 v[116:119], a[88:91], v[96:99], v[116:119]
    s_waitcnt lgkmcnt(0)
    v_max3_f32 v78, v72, v73, v74
    v_max_f32 v78, v78, v75
    v_mfma_f32_16x16x32_bf16 v[112:115], a[76:79], v[100:103], v[112:115]
    v_sub_f32 v78, v76, v78
    v_exp_f32 v78, v78
    v_mfma_f32_16x16x32_bf16 v[116:119], a[92:95], v[100:103], v[116:119]
    v_mul_f32 v120, v120, v78
    ds_write_b32 v20, v120 offset:64
    v_mov_b32 v4, v4
    v_mov_b32 v4, v4
    v_mov_b32 v4, v4
    v_pk_mul_f32 v[112:113], v[112:113], v[78:79] op_sel_hi:[1,0]
    v_pk_mul_f32 v[114:115], v[114:115], v[78:79] op_sel_hi:[1,0]
    ds_write_b128 v19, v[112:115] offset:0
    v_pk_mul_f32 v[116:117], v[116:117], v[78:79] op_sel_hi:[1,0]
    v_pk_mul_f32 v[118:119], v[118:119], v[78:79] op_sel_hi:[1,0]
    ds_write_b128 v19, v[116:119] offset:256
    s_waitcnt lgkmcnt(0)
    s_barrier
    ds_read_b64 v[112:113], v21 offset:0
    ds_read_b64 v[114:115], v21 offset:2112
    ds_read_b64 v[116:117], v21 offset:4224
    ds_read_b64 v[118:119], v21 offset:6336
    s_waitcnt lgkmcnt(2)
    v_pk_add_f32 v[112:113], v[112:113], v[114:115]
    s_waitcnt lgkmcnt(0)
    v_pk_add_f32 v[116:117], v[116:117], v[118:119]
    v_pk_add_f32 v[112:113], v[112:113], v[116:117]
    v_cvt_pk_bf16_f32 v112, v112, v113
    buffer_store_dword v112, v23, s[36:39], s54 offen
    s_cmp_lg_u32 s40, 0
    s_cbranch_scc1 L_stub5
L_stub5_r:
    s_nop 15
    s_nop 15
    s_nop 15
    s_nop 3
L_or:
    buffer_load_dwordx4 v[40:43], v31, s[32:35], s21 offen sc1
    s_nop 9
    buffer_load_dwordx4 v[44:47], v32, s[32:35], s21 offen sc1
    s_nop 9
    buffer_load_dwordx4 v[48:51], v33, s[32:35], s21 offen sc1
    s_nop 9
    buffer_load_dwordx4 v[52:55], v34, s[32:35], s21 offen sc1
    s_branch L_or_0
L_pad10:
    s_setpc_b64 s[12:13]
L_or_f3:
    buffer_load_dwordx4 v[52:55], v34, s[32:35], s21 offen sc1
    s_sub_i32 s49, s49, 1
    s_cmp_gt_i32 s49, 0
    s_cselect_b32 s50, -2, -1
L_or_0:
    s_waitcnt vmcnt(3)
    v_mfma_f32_16x16x32_bf16 v[72:75], v[40:43], a[96:99], 0
    v_max_u32 v4, v40, v43
    v_cmp_lt_u32 vcc, s50, v4
    v_mfma_f32_16x16x32_bf16 v[76:79], v[40:43], a[112:115], 0
    s_cbranch_vccnz L_or_f0
    v_max3_u32 v4, v4, v41, v42
    s_waitcnt vmcnt(2)
    v_mfma_f32_16x16x32_bf16 v[72:75], v[44:47], a[100:103], v[72:75]
    v_max3_u32 v4, v4, v44, v47
    v_mfma_f32_16x16x32_bf16 v[76:79], v[44:47], a[116:119], v[76:79]
    v_max3_u32 v4, v4, v45, v46
    s_waitcnt vmcnt(1)
    v_mfma_f32_16x16x32_bf16 v[72:75], v[48:51], a[104:107], v[72:75]
    v_max3_u32 v4, v4, v48, v51
    v_mfma_f32_16x16x32_bf16 v[76:79], v[48:51], a[120:123], v[76:79]
    v_max3_u32 v4, v4, v49, v50
    s_waitcnt vmcnt(0)
    v_mfma_f32_16x16x32_bf16 v[72:75], v[52:55], a[108:111], v[72:75]
    v_max3_u32 v4, v4, v52, v55
    ds_read_b128 v[116:119], v24
    v_mfma_f32_16x16x32_bf16 v[76:79], v[52:55], a[124:127], v[76:79]
    v_max3_u32 v4, v4, v53, v54
    s_branch L_or_done
L_or_f0:
    buffer_load_dwordx4 v[40:43], v31, s[32:35], s21 offen sc1
L_or_1:
    s_waitcnt vmcnt(3)
    v_mfma_f32_16x16x32_bf16 v[72:75], v[44:47], a[100:103], 0
    v_max_u32 v4, v44, v47
    v_cmp_lt_u32 vcc, s50, v4
    v_mfma_f32_16x16x32_bf16 v[76:79], v[44:47], a[116:119], 0
    s_cbranch_vccnz L_or_f1
    v_max3_u32 v4, v4, v45, v46
    s_waitcnt vmcnt(2)
    v_mfma_f32_16x16x32_bf16 v[72:75], v[48:51], a[104:107], v[72:75]
    v_max3_u32 v4, v4, v48, v51
    v_mfma_f32_16x16x32_bf16 v[76:79], v[48:51], a[120:123], v[76:79]
    v_max3_u32 v4, v4, v49, v50
    s_waitcnt vmcnt(1)
    v_mfma_f32_16x16x32_bf16 v[72:75], v[52:55], a[108:111], v[72:75]
    v_max3_u32 v4, v4, v52, v55
    v_mfma_f32_16x16x32_bf16 v[76:79], v[52:55], a[124:127], v[76:79]
    v_max3_u32 v4, v4, v53, v54
    s_waitcnt vmcnt(0)
    v_mfma_f32_16x16x32_bf16 v[72:75], v[40:43], a[96:99], v[72:75]
    v_max3_u32 v4, v4, v40, v43
    ds_read_b128 v[116:119], v24
    v_mfma_f32_16x16x32_bf16 v[76:79], v[40:43], a[112:115], v[76:79]
    v_max3_u32 v4, v4, v41, v42
    s_branch L_or_done
L_or_f1:
    buffer_load_dwordx4 v[44:47], v32, s[32:35], s21 offen sc1
L_or_2:
    s_waitcnt vmcnt(3)
    v_mfma_f32_16x16x32_bf16 v[72:75], v[48:51], a[104:107], 0
    v_max_u32 v4, v48, v51
    v_cmp_lt_u32 vcc, s50, v4
    v_mfma_f32_16x16x32_bf16 v[76:79], v[48:51], a[120:123], 0
    s_cbranch_vccnz L_or_f2
    v_max3_u32 v4, v4, v49, v50
    s_waitcnt vmcnt(2)
    v_mfma_f32_16x16x32_bf16 v[72:75], v[52:55], a[108:111], v[72:75]
    v_max3_u32 v4, v4, v52, v55
    v_mfma_f32_16x16x32_bf16 v[76:79], v[52:55], a[124:127], v[76:79]
    v_max3_u32 v4, v4, v53, v54
    s_waitcnt vmcnt(1)
    v_mfma_f32_16x16x32_bf16 v[72:75], v[40:43], a[96:99], v[72:75]
    v_max3_u32 v4, v4, v40, v43
    v_mfma_f32_16x16x32_bf16 v[76:79], v[40:43], a[112:115], v[76:79]
    v_max3_u32 v4, v4, v41, v42
    s_waitcnt vmcnt(0)
    v_mfma_f32_16x16x32_bf16 v[72:75], v[44:47], a[100:103], v[72:75]
    v_max3_u32 v4, v4, v44, v47
    ds_read_b128 v[116:119], v24
    v_mfma_f32_16x16x32_bf16 v[76:79], v[44:47], a[116:119], v[76:79]
    v_max3_u32 v4, v4, v45, v46
    s_branch L_or_done
L_pad11:
    s_setpc_b64 s[12:13]
L_or_f2:
    buffer_load_dwordx4 v[48:51], v33, s[32:35], s21 offen sc1
L_or_3:
    s_waitcnt vmcnt(3)
    v_mfma_f32_16x16x32_bf16 v[72:75], v[52:55], a[108:111], 0
    v_max_u32 v4, v52, v55
    v_cmp_lt_u32 vcc, s50, v4
    v_mfma_f32_16x16x32_bf16 v[76:79], v[52:55], a[124:127], 0
    s_cbranch_vccnz L_or_f3
    v_max3_u32 v4, v4, v53, v54
    s_waitcnt vmcnt(2)
    v_mfma_f32_16x16x32_bf16 v[72:75], v[40:43], a[96:99], v[72:75]
    v_max3_u32 v4, v4, v40, v43
    v_mfma_f32_16x16x32_bf16 v[76:79], v[40:43], a[112:115], v[76:79]
    v_max3_u32 v4, v4, v41, v42
    s_waitcnt vmcnt(1)
    v_mfma_f32_16x16x32_bf16 v[72:75], v[44:47], a[100:103], v[72:75]
    v_max3_u32 v4, v4, v44, v47
    v_mfma_f32_16x16x32_bf16 v[76:79], v[44:47], a[116:119], v[76:79]
    v_max3_u32 v4, v4, v45, v46
    s_waitcnt vmcnt(0)
    v_mfma_f32_16x16x32_bf16 v[72:75], v[48:51], a[104:107], v[72:75]
    v_max3_u32 v4, v4, v48, v51
    ds_read_b128 v[116:119], v24
    v_mfma_f32_16x16x32_bf16 v[76:79], v[48:51], a[120:123], v[76:79]
    v_max3_u32 v4, v4, v49, v50
L_or_done:
    v_cmp_lt_u32 vcc, s50, v4
    s_sub_i32 s49, s49, 1
    s_cmp_gt_i32 s49, 0
    s_cselect_b32 s50, -2, -1
    s_cbranch_vccnz L_or
L_or_w:
    s_waitcnt lgkmcnt(0)
    v_cmp_lt_u32 vcc, s50, v116
    v_pk_mul_f32 v[112:113], v[116:117], v[72:73]
    v_pk_fma_f32 v[112:113], v[118:119], v[74:75], v[112:113]
    v_pk_mul_f32 v[114:115], v[116:117], v[76:77]
    v_pk_fma_f32 v[114:115], v[118:119], v[78:79], v[114:115]
    v_add_f32 v112, v112, v113
    v_add_f32 v113, v114, v115
    s_cbranch_vccnz L_or_r
    s_nop 0
    v_permlane16_swap_b32 v112, v113
    v_add_f32 v112, v112, v113
    ds_write_b32 v25, v112
    s_waitcnt lgkmcnt(0)
    s_barrier
    s_lshl2_add_u32 s3, s53, s44
    s_lshl3_add_u32 s54, s53, s44
    s_lshl_b32 s54, s54, 11
    s_add_u32 s54, s54, 0x1a0000
    s_add_u32 s55, s60, s51
    s_add_u32 s55, s55, 114688
    s_add_u32 s62, s56, 3
    s_add_u32 s54, s54, s43
    s_barrier
    s_nop 15
    s_nop 15
    s_nop 15
    s_nop 15
    s_nop 15
    s_nop 15
    s_nop 15
    s_nop 15
    s_nop 1
    buffer_load_dwordx4 v[40:43], v8, s[32:35], s54 offen sc1
    buffer_load_dwordx4 v[44:47], v8, s[32:35], s54 offen offset:1024 sc1
    s_branch L_p1u1_0
L_pad12:
    s_setpc_b64 s[12:13]
L_p1u1_f0:
    buffer_load_dwordx4 v[40:43], v8, s[32:35], s54 offen sc1
    buffer_load_dwordx4 v[44:47], v8, s[32:35], s54 offen offset:1024 sc1
    s_sub_i32 s49, s49, 1
    s_cmp_gt_i32 s49, 0
    s_cselect_b32 s58, 0, -1
L_p1u1_0:
    s_waitcnt vmcnt(0)
    v_pk_add_f32 v[104:105], v[40:41], v[44:45]
    v_pk_add_f32 v[106:107], v[42:43], v[46:47]
    v_bitop3_b32 v4, v40, v44, s56 bitop3:0x7e
    v_and_b32 v4, 0xff, v4
    v_permlane32_swap_b32 v104, v106
    v_permlane32_swap_b32 v105, v107
    v_pk_add_f32 v[104:105], v[104:105], v[106:107]
    v_cmp_lt_u32 vcc, s58, v4
    s_cbranch_vccnz L_p1u1_f0
    v_permlane16_swap_b32 v104, v105
    v_add_f32 v104, v104, v105
    v_cvt_pk_bf16_f32 v104, v104, v104
    v_and_b32 v104, 0xffff0000, v104
    v_add_f32 v104, v104, v26
    v_cvt_pk_bf16_f32 v104, v104, v104
    ds_write_b16 v14, v104 offset:1536
L_p1u1_done:
    v_and_b32 v26, 0xffff0000, v104
    s_cmp_eq_u32 s45, 7
    s_cbranch_scc1 L_p1u1_skip
    s_waitcnt lgkmcnt(0)
    s_barrier
    ds_read_b128 v[108:111], v12 offset:1536
    ds_read_b128 v[112:115], v12 offset:1792
    ds_read_b128 v[116:119], v15 offset:1536
    ds_read_b128 v[120:123], v15 offset:1792
    s_waitcnt lgkmcnt(3)
    v_mfma_f32_16x16x32_bf16 v[72:75], v[108:111], a[16:19], 0
    s_waitcnt lgkmcnt(2)
    v_mfma_f32_16x16x32_bf16 v[72:75], v[112:115], a[20:23], v[72:75]
    s_waitcnt lgkmcnt(1)
    v_mfma_f32_16x16x32_bf16 v[72:75], v[116:119], a[24:27], v[72:75]
    s_waitcnt lgkmcnt(0)
    v_mfma_f32_16x16x32_bf16 v[72:75], v[120:123], a[28:31], v[72:75]
    s_nop 7
    v_bfi_b32 v72, v10, s62, v72
    buffer_store_dwordx4 v[72:75], v17, s[36:39], s55 offen
    s_cmp_lg_u32 s40, 0
    s_cbranch_scc1 L_stub6
L_stub6_r:
L_p1u1_skip:
    s_cmp_lg_u32 s53, s45
    s_cbranch_scc1 L_mend
    s_cmp_lg_u32 s52, 0
    s_cbranch_scc1 L_mend
    s_mov_b32 s4, s26
    s_mov_b32 s5, s27
    s_mov_b32 s6, 0x1000
    s_lshl2_add_u32 s3, s53, s44
    s_lshl3_add_u32 s54, s53, s44
    s_lshl_b32 s54, s54, 11
    s_add_u32 s54, s54, 0x1c0000
    s_lshl_b32 s55, s3, 5
    s_add_u32 s54, s54, s43
    s_cmp_lg_u32 s45, 7
    s_cbranch_scc1 L_p1f1_b
    s_sleep 34
    s_branch L_p1f1_p
L_p1f1_b:
    s_barrier
    s_nop 15
    s_nop 15
    s_nop 15
    s_nop 15
    s_nop 15
    s_nop 15
    s_nop 15
    s_nop 15
    s_nop 1
L_p1f1_p:
    buffer_load_dwordx4 v[40:43], v8, s[32:35], s54 offen sc1
    buffer_load_dwordx4 v[44:47], v8, s[32:35], s54 offen offset:1024 sc1
    s_branch L_p1f1_0
L_p1f1_f0:
    buffer_load_dwordx4 v[40:43], v8, s[32:35], s54 offen sc1
    buffer_load_dwordx4 v[44:47], v8, s[32:35], s54 offen offset:1024 sc1
    s_sub_i32 s49, s49, 1
    s_cmp_gt_i32 s49, 0
    s_cselect_b32 s58, 0, -1
L_p1f1_0:
    s_waitcnt vmcnt(0)
    v_pk_add_f32 v[104:105], v[40:41], v[44:45]
    v_pk_add_f32 v[106:107], v[42:43], v[46:47]
    v_bitop3_b32 v4, v40, v44, s56 bitop3:0x7e
    v_and_b32 v4, 0xff, v4
    v_permlane32_swap_b32 v104, v106
    v_permlane32_swap_b32 v105, v107
    v_pk_add_f32 v[104:105], v[104:105], v[106:107]
    v_cmp_lt_u32 vcc, s58, v4
    s_cbranch_vccnz L_p1f1_f0
    v_permlane16_swap_b32 v104, v105
    v_add_f32 v104, v104, v105
    v_cvt_pk_bf16_f32 v104, v104, v104
    v_and_b32 v104, 0xffff0000, v104
    v_add_f32 v104, v104, v26
    v_cvt_pk_bf16_f32 v104, v104, v104
    buffer_store_short v104, v27, s[4:7], s55 offen
L_p1f1_done:
    s_or_b32 s54, s2, s44
    s_cselect_b32 s54, 0x40000000, 0x1f8000
    s_add_u32 s3, s56, 3
    v_mov_b32 v105, s3
    buffer_store_dword v105, v9, s[32:35], s54 offen
L_mend:
    s_endpgm
L_or_r:
    ds_read_b128 v[116:119], v24
    s_sub_i32 s49, s49, 1
    s_cmp_gt_i32 s49, 0
    s_cselect_b32 s50, -2, -1
    s_branch L_or_w
L_pad13:
    s_setpc_b64 s[12:13]
L_comm:
    s_setprio 2
    s_lshr_b32 s47, s2, 6
    s_and_b32 s48, s46, 7
    s_mov_b32 s39, 0x00020000
    v_mov_b32 v11, 0x40000000
    s_mul_i32 s59, s45, 0x100
    s_add_u32 s59, s59, 0x1e0000
    s_mov_b32 s49, 0x20000
    s_mov_b32 s50, -2
    s_mov_b32 s58, 0
    s_mov_b32 s38, 0x500000
    s_mov_b32 s40, 0
    s_mul_i32 s63, s44, 8192
    v_lshlrev_b32 v7, 2, v1
    s_mov_b64 s[32:33], s[30:31]
    s_mov_b64 s[36:37], s[30:31]
    s_lshl3_add_u32 s60, s53, s52
    s_lshl3_add_u32 s60, s60, s45
    s_lshl_b32 s60, s60, 8
    s_add_u32 s60, s60, 0x160000
    v_mov_b32 v4, 0
    v_cmp_eq_u32 vcc, 0, v1
    s_nop 1
    v_cndmask_b32 v9, v11, v4, vcc
    v_mov_b32 v10, 0xff
    v_lshlrev_b32 v5, 4, v3
    v_lshl_add_u32 v5, v2, 6, v5
    v_cmp_gt_u32 vcc, 4, v3
    v_mov_b32 v6, 512
    s_nop 0
    v_cndmask_b32 v12, v6, v5, vcc
    v_add_u32 v12, 150016, v12
    v_mov_b32 v88, 0x3f803f80
    v_mov_b32 v89, 0x3f803f80
    v_lshlrev_b32 v4, 3, v1
    v_add_u32 v4, 150528, v4
    ds_write_b64 v4, v[88:89]
    ds_write_b64 v4, v[88:89] offset:1536
    v_mov_b32 v90, 0
    v_mov_b32 v91, 0
    ds_write_b64 v4, v[90:91] offset:512
    ds_write_b64 v4, v[90:91] offset:2048
    v_add_u32 v22, 154368, v7
    v_mov_b32 v92, -1
    ds_write_b32 v22, v92
    v_and_b32 v4, 7, v3
    v_lshlrev_b32 v4, 1, v4
    v_lshrrev_b32 v5, 3, v3
    v_lshl_add_u32 v14, v2, 10, v4
    v_lshl_add_u32 v14, v5, 8, v14
    v_lshl_add_u32 v15, v2, 4, v4
    v_lshl_add_u32 v15, v5, 30, v15
    v_and_b32 v4, 1, v2
    v_lshlrev_b32 v16, 11, v4
    v_lshrrev_b32 v4, 1, v2
    v_lshl_add_u32 v16, v4, 6, v16
    v_lshl_add_u32 v16, v3, 2, v16
    v_add_u32 v17, 147968, v7
    v_cmp_gt_u32 vcc, 4, v3
    v_lshlrev_b32 v4, 2, v2
    v_lshl_add_u32 v5, v3, 6, v4
    v_cndmask_b32 v5, v11, v5, vcc
    v_cmp_gt_u32 vcc, 32, v1
    s_nop 1
    v_cndmask_b32 v18, v11, v5, vcc
    v_and_b32 v4, 3, v3
    v_lshlrev_b32 v21, 2, v3
    v_cmp_eq_u32 s[10:11], 1, v4
    v_cmp_eq_u32 s[12:13], 2, v4
    v_cmp_eq_u32 s[14:15], 3, v4
    s_branch L_over14
.p2align 12
L_pad14:
    s_setpc_b64 s[12:13]
L_over14:
    s_waitcnt vmcnt(0)
    v_dot2_f32_bf16 v90, v24, v24, 0
    v_dot2_f32_bf16 v90, v25, v25, v90
    v_dot2_f32_bf16 v90, v26, v26, v90
    v_dot2_f32_bf16 v90, v27, v27, v90
    v_dot2_f32_bf16 v90, v28, v28, v90
    v_dot2_f32_bf16 v90, v29, v29, v90
    v_dot2_f32_bf16 v90, v30, v30, v90
    v_dot2_f32_bf16 v90, v31, v31, v90
    v_dot2_f32_bf16 v90, v32, v32, v90
    v_dot2_f32_bf16 v90, v33, v33, v90
    v_dot2_f32_bf16 v90, v34, v34, v90
    v_dot2_f32_bf16 v90, v35, v35, v90
    v_dot2_f32_bf16 v90, v36, v36, v90
    v_dot2_f32_bf16 v90, v37, v37, v90
    v_dot2_f32_bf16 v90, v38, v38, v90
    v_dot2_f32_bf16 v90, v39, v39, v90
    v_dot2_f32_bf16 v91, v24, v88, 0
    v_dot2_f32_bf16 v91, v25, v88, v91
    v_dot2_f32_bf16 v91, v26, v88, v91
    v_dot2_f32_bf16 v91, v27, v88, v91
    v_dot2_f32_bf16 v91, v28, v88, v91
    v_dot2_f32_bf16 v91, v29, v88, v91
    v_dot2_f32_bf16 v91, v30, v88, v91
    v_dot2_f32_bf16 v91, v31, v88, v91
    v_dot2_f32_bf16 v91, v32, v88, v91
    v_dot2_f32_bf16 v91, v33, v88, v91
    v_dot2_f32_bf16 v91, v34, v88, v91
    v_dot2_f32_bf16 v91, v35, v88, v91
    v_dot2_f32_bf16 v91, v36, v88, v91
    v_dot2_f32_bf16 v91, v37, v88, v91
    v_dot2_f32_bf16 v91, v38, v88, v91
    v_dot2_f32_bf16 v91, v39, v88, v91
    s_nop 3
    v_add_f32_dpp v90, v90, v90 row_ror:4 row_mask:0xf bank_mask:0xf
    v_add_f32_dpp v91, v91, v91 row_ror:4 row_mask:0xf bank_mask:0xf
    s_nop 1
    v_add_f32_dpp v90, v90, v90 row_ror:8 row_mask:0xf bank_mask:0xf
    v_add_f32_dpp v91, v91, v91 row_ror:8 row_mask:0xf bank_mask:0xf
    s_nop 1
    v_mov_b32 v92, v90
    v_mov_b32 v93, v91
    s_nop 1
    v_permlane16_swap_b32 v90, v92
    v_permlane16_swap_b32 v91, v93
    v_pk_add_f32 v[90:91], v[90:91], v[92:93]
    v_mov_b32 v92, v90
    v_mov_b32 v93, v91
    s_nop 1
    v_permlane32_swap_b32 v90, v92
    v_permlane32_swap_b32 v91, v93
    v_pk_add_f32 v[90:91], v[90:91], v[92:93]
    v_mov_b32 v94, 0x3727c5ac
    v_fmac_f32 v94, 0x3b000000, v90
    v_mul_f32 v92, 0x3b000000, v91
    v_fma_f32 v94, -v92, v92, v94
    v_max_f32 v94, 0x3727c5ac, v94
    v_rsq_f32 v93, v94
    v_lshlrev_b32 v4, 3, v4
    v_mul_f32 v93, 0x3e0293ee, v93
    v_add_u32 v4, 154112, v4
    ds_write_b64 v4, v[92:93]
    s_waitcnt lgkmcnt(0)
    s_add_u32 s56, s56, 1
    s_getreg_b32 s3, hwreg(HW_REG_XCC_ID, 0, 4)
    s_lshl_b32 s3, s3, 8
    s_and_b32 s57, s56, 0xff
    s_or_b32 s57, s57, s3
    s_barrier
    v_lshrrev_b32 v4, 3, v1
    v_and_b32 v5, 7, v1
    v_lshlrev_b32 v6, 4, v5
    v_lshl_add_u32 v6, v4, 12, v6
    s_lshl_b32 s3, s47, 7
    s_add_u32 s54, s51, s3
    s_add_u32 s54, s54, 0x1c000
    s_lshl_b32 s61, s45, 16
    s_add_u32 s61, s61, s3
    s_add_u32 s61, s61, 0x400000
    v_bfe_u32 v116, v1, 1, 2
    v_lshlrev_b32 v116, 8, v116
    v_bfe_u32 v4, v1, 3, 2
    v_lshl_add_u32 v116, v4, 6, v116
    v_lshrrev_b32 v4, 5, v1
    v_lshl_add_u32 v116, v4, 4, v116
    v_and_b32 v4, 1, v1
    v_lshl_add_u32 v116, v4, 3, v116
    v_add_u32 v116, 153088, v116
    s_barrier
    s_mov_b32 s42, 0
    s_branch L_q0_ld
L_pad15:
    s_setpc_b64 s[12:13]
L_q0:
    s_add_u32 s42, s42, 1
    s_cmp_ge_u32 s42, 3
    s_cbranch_scc1 L_prep
L_q0_ld:
    s_add_u32 s55, s54, 32768
    buffer_load_dwordx4 v[24:27], v6, s[32:35], s54 offen offset:0 sc1
    buffer_load_dwordx4 v[28:31], v6, s[32:35], s54 offen offset:512 sc1
    buffer_load_dwordx4 v[32:35], v6, s[32:35], s54 offen offset:1024 sc1
    buffer_load_dwordx4 v[36:39], v6, s[32:35], s54 offen offset:1536 sc1
    buffer_load_dwordx4 v[40:43], v6, s[32:35], s54 offen offset:2048 sc1
    buffer_load_dwordx4 v[44:47], v6, s[32:35], s54 offen offset:2560 sc1
    buffer_load_dwordx4 v[48:51], v6, s[32:35], s54 offen offset:3072 sc1
    buffer_load_dwordx4 v[52:55], v6, s[32:35], s54 offen offset:3584 sc1
    buffer_load_dwordx4 v[56:59], v6, s[32:35], s55 offen offset:0 sc1
    buffer_load_dwordx4 v[60:63], v6, s[32:35], s55 offen offset:512 sc1
    buffer_load_dwordx4 v[64:67], v6, s[32:35], s55 offen offset:1024 sc1
    buffer_load_dwordx4 v[68:71], v6, s[32:35], s55 offen offset:1536 sc1
    buffer_load_dwordx4 v[72:75], v6, s[32:35], s55 offen offset:2048 sc1
    buffer_load_dwordx4 v[76:79], v6, s[32:35], s55 offen offset:2560 sc1
    buffer_load_dwordx4 v[80:83], v6, s[32:35], s55 offen offset:3072 sc1
    buffer_load_dwordx4 v[84:87], v6, s[32:35], s55 offen offset:3584 sc1
    s_cmp_lg_u32 s42, 0
    s_cbranch_scc1 1
    s_barrier
    s_sub_i32 s49, s49, 1
    s_cmp_gt_i32 s49, 0
    s_cselect_b32 s58, 0, -1
    s_waitcnt vmcnt(0)
    v_xor_b32 v4, s57, v24
    v_bitop3_b32 v4, v4, v28, s57 bitop3:0xf6
    v_bitop3_b32 v4, v4, v32, s57 bitop3:0xf6
    v_bitop3_b32 v4, v4, v36, s57 bitop3:0xf6
    v_bitop3_b32 v4, v4, v40, s57 bitop3:0xf6
    v_bitop3_b32 v4, v4, v44, s57 bitop3:0xf6
    v_bitop3_b32 v4, v4, v48, s57 bitop3:0xf6
    v_bitop3_b32 v4, v4, v52, s57 bitop3:0xf6
    v_bitop3_b32 v4, v4, v56, s57 bitop3:0xf6
    v_bitop3_b32 v4, v4, v60, s57 bitop3:0xf6
    v_bitop3_b32 v4, v4, v64, s57 bitop3:0xf6
    v_bitop3_b32 v4, v4, v68, s57 bitop3:0xf6
    v_bitop3_b32 v4, v4, v72, s57 bitop3:0xf6
    v_bitop3_b32 v4, v4, v76, s57 bitop3:0xf6
    v_bitop3_b32 v4, v4, v80, s57 bitop3:0xf6
    v_bitop3_b32 v4, v4, v84, s57 bitop3:0xf6
    v_and_b32 v5, v4, v10
    v_cmp_lt_u32 vcc, s58, v5
    s_cbranch_vccnz L_q0
    v_pk_add_f32 v[24:25], v[24:25], v[40:41]
    v_pk_add_f32 v[26:27], v[26:27], v[42:43]
    v_pk_add_f32 v[28:29], v[28:29], v[44:45]
    v_pk_add_f32 v[30:31], v[30:31], v[46:47]
    v_pk_add_f32 v[32:33], v[32:33], v[48:49]
    v_pk_add_f32 v[34:35], v[34:35], v[50:51]
    v_pk_add_f32 v[36:37], v[36:37], v[52:53]
    v_pk_add_f32 v[38:39], v[38:39], v[54:55]
    v_pk_add_f32 v[24:25], v[24:25], v[32:33]
    v_pk_add_f32 v[26:27], v[26:27], v[34:35]
    v_pk_add_f32 v[28:29], v[28:29], v[36:37]
    v_pk_add_f32 v[30:31], v[30:31], v[38:39]
    v_pk_add_f32 v[24:25], v[24:25], v[28:29]
    v_pk_add_f32 v[26:27], v[26:27], v[30:31]
    v_cvt_pk_bf16_f32 v24, v24, v25
    v_cvt_pk_bf16_f32 v25, v26, v27
    ds_write_b64 v116, v[24:25] offset:0
    v_pk_add_f32 v[56:57], v[56:57], v[72:73]
    v_pk_add_f32 v[58:59], v[58:59], v[74:75]
    v_pk_add_f32 v[60:61], v[60:61], v[76:77]
    v_pk_add_f32 v[62:63], v[62:63], v[78:79]
    v_pk_add_f32 v[64:65], v[64:65], v[80:81]
    v_pk_add_f32 v[66:67], v[66:67], v[82:83]
    v_pk_add_f32 v[68:69], v[68:69], v[84:85]
    v_pk_add_f32 v[70:71], v[70:71], v[86:87]
    v_pk_add_f32 v[56:57], v[56:57], v[64:65]
    v_pk_add_f32 v[58:59], v[58:59], v[66:67]
    v_pk_add_f32 v[60:61], v[60:61], v[68:69]
    v_pk_add_f32 v[62:63], v[62:63], v[70:71]
    v_pk_add_f32 v[56:57], v[56:57], v[60:61]
    v_pk_add_f32 v[58:59], v[58:59], v[62:63]
    v_cvt_pk_bf16_f32 v56, v56, v57
    v_cvt_pk_bf16_f32 v57, v58, v59
    ds_write_b64 v116, v[56:57] offset:32
    v_and_b32 v4, 0xf00, v4
    v_cmp_ne_u32 vcc, 0, v4
    s_cbranch_vccnz L_slow
L_slow_ret:
    v_mov_b32 v4, 154144
    v_mov_b32 v5, s40
    ds_write_b32 v4, v5
    s_cmp_eq_u32 s40, 0
    s_cselect_b32 s38, 0x500000, 0
    s_cselect_b32 s41, 0, 0x200000
    s_add_u32 s51, s51, s41
    s_waitcnt lgkmcnt(0)
    s_barrier
    s_branch L_over16
L_pad16:
    s_setpc_b64 s[12:13]
L_over16:
    s_and_b32 s3, s46, 1
    s_mul_i32 s3, s3, -1920
    s_add_u32 s20, s60, s3
    s_sub_u32 s54, s56, 1
    s_and_b32 s54, s54, 0xff
    s_and_b32 s3, s56, 0xff
    s_cmp_eq_u32 s45, 7
    s_cselect_b32 s3, s3, s54
    v_mov_b32 v88, s54
    v_mov_b32 v89, s3
    s_bitcmp1_b32 s46, 0
    s_cselect_b32 s55, 0x40000000, s60
    s_add_u32 s54, s55, 0x0
    buffer_store_dword v88, v16, s[32:35], s54 offen offset:0 sc1
    buffer_store_dword v88, v16, s[32:35], s54 offen offset:128 sc1
    s_add_u32 s54, s55, 0x2000
    buffer_store_dword v88, v16, s[32:35], s54 offen offset:0 sc1
    buffer_store_dword v88, v16, s[32:35], s54 offen offset:128 sc1
    s_add_u32 s54, s60, 0x20000
    buffer_store_dword v89, v7, s[32:35], s54 offen sc1
    s_add_u32 s54, s60, 0x22000
    buffer_store_dword v89, v7, s[32:35], s54 offen sc1
    s_add_u32 s54, s20, 0x40000
    buffer_store_dword v88, v16, s[32:35], s54 offen sc1
    s_add_u32 s54, s20, 0x42000
    buffer_store_dword v88, v16, s[32:35], s54 offen sc1
    s_add_u32 s54, s60, 0x60000
    buffer_store_dword v89, v7, s[32:35], s54 offen sc1
    s_add_u32 s54, s60, 0x62000
    buffer_store_dword v89, v7, s[32:35], s54 offen sc1
    s_barrier
    s_barrier
    s_lshr_b32 s41, s46, 1
    s_lshl2_add_u32 s41, s41, s51
    s_add_u32 s41, s41, 55296
    s_bitcmp1_b32 s46, 0
    s_cbranch_scc1 L_c_odd
    s_barrier
    v_add_u32 v4, 1024, v17
    s_add_u32 s55, s20, 0x0
    v_mov_b32 v6, 154160
    ds_read_b128 v[88:91], v6
    v_mov_b32 v5, 8192
    s_waitcnt lgkmcnt(0)
    v_add3_u32 v88, v88, v89, v90
    v_add_u32 v88, v88, v91
    v_cmp_le_u32 vcc, 64, v88
    v_mov_b32 v6, 154148
    s_nop 0
    v_cndmask_b32 v5, 0, v5, vcc
    ds_write_b32 v6, v5
    v_readfirstlane_b32 s43, v5
    s_waitcnt lgkmcnt(0)
    s_add_u32 s55, s55, s43
    s_xor_b32 s54, s55, 8192
    s_barrier
    ds_read2_b32 v[88:89], v17 offset0:0 offset1:64
    ds_read2_b32 v[90:91], v17 offset0:128 offset1:192
    ds_read2_b32 v[92:93], v4 offset0:0 offset1:64
    ds_read2_b32 v[94:95], v4 offset0:128 offset1:192
    buffer_store_dword v5, v9, s[36:39], s41 offen
    s_cmp_lg_u32 s40, 0
    s_cbranch_scc1 L_stub7
L_stub7_r:
    s_waitcnt lgkmcnt(2)
    v_pk_add_f32 v[88:89], v[88:89], v[90:91]
    v_add_f32 v88, v88, v89
    v_bfi_b32 v88, v10, s56, v88
    buffer_store_dword v88, v16, s[32:35], s54 offen offset:0 sc1
    s_waitcnt lgkmcnt(0)
    v_pk_add_f32 v[92:93], v[92:93], v[94:95]
    v_add_f32 v92, v92, v93
    v_bfi_b32 v92, v10, s56, v92
    buffer_store_dword v92, v16, s[32:35], s54 offen offset:128 sc1
    buffer_store_dword v88, v16, s[32:35], s55 offen offset:0 sc1
    buffer_store_dword v92, v16, s[32:35], s55 offen offset:128 sc1
    s_barrier
    s_branch L_c_join
L_c_odd:
    s_barrier
    v_mov_b32 v5, 0
L_c_tw:
    buffer_load_dword v4, v5, s[32:35], s41 offen sc1
    s_sub_i32 s49, s49, 1
    s_cmp_gt_i32 s49, 0
    s_cselect_b32 s50, -2, -1
    s_waitcnt vmcnt(0)
    v_cmp_lt_u32 vcc, s50, v4
    s_cbranch_vccnz L_c_tw
    v_and_b32 v4, 8192, v4
    v_mov_b32 v5, 154148
    ds_write_b32 v5, v4
    v_readfirstlane_b32 s43, v4
    s_waitcnt lgkmcnt(0)
    s_barrier
L_c_join:
    s_cmp_eq_u32 s45, 7
    s_cbranch_scc1 L_c_skip0
    s_branch L_over17
L_pad17:
    s_setpc_b64 s[12:13]
L_over17:
    s_add_u32 s62, s56, 1
    s_lshl_b32 s3, s52, 5
    s_add_u32 s3, s3, s53
    s_lshl3_add_u32 s3, s3, s51
    s_add_u32 s3, s3, 52224
    s_lshl_b32 s54, s46, 11
    s_add_u32 s54, s54, s51
    s_add_u32 s54, s54, 114688
    s_lshl_b32 s55, s47, 8
    s_add_u32 s55, s55, s51
    s_add_u32 s55, s55, 52224
    s_lshr_b32 s41, s46, 4
    s_lshl2_add_u32 s41, s41, s52
    s_and_b32 s61, s53, 3
    s_lshl2_add_u32 s41, s41, s61
    s_lshl_b32 s41, s41, 6
    s_add_u32 s41, s41, s51
    s_add_u32 s41, s41, 49152
    s_add_u32 s42, s51, 49152
    s_add_u32 s61, s60, 0x22000
    s_sub_u32 s61, s61, s43
    s_barrier
    s_bitcmp0_b32 s46, 0
    s_cbranch_scc1 L_c_nostat
    ds_read_b128 v[88:91], v12 offset:1536
    ds_read_b128 v[92:95], v12 offset:1792
    s_waitcnt lgkmcnt(1)
    v_mfma_f32_16x16x32_bf16 v[116:119], v[88:91], v[88:91], 0
    s_waitcnt lgkmcnt(0)
    v_mfma_f32_16x16x32_bf16 v[116:119], v[92:95], v[92:95], v[116:119]
    s_nop 7
    v_cndmask_b32 v116, v116, v117, s[10:11]
    v_cndmask_b32 v116, v116, v118, s[12:13]
    v_cndmask_b32 v116, v116, v119, s[14:15]
    s_sub_u32 s3, s3, 256
    buffer_store_dword v116, v18, s[36:39], s3 offen offset:256
    buffer_store_dword v116, v18, s[36:39], s3 offen
    s_cmp_lg_u32 s40, 0
    s_cbranch_scc1 L_stub8
L_stub8_r:
L_c_nostat:
    s_lshl_b32 s3, s46, 9
    s_add_u32 s3, s3, s51
    s_add_u32 s3, s3, 32768
L_csu:
    buffer_load_dword v72, v21, s[32:35], s3 offen offset:0 sc1
    buffer_load_dword v73, v21, s[32:35], s3 offen offset:64 sc1
    buffer_load_dword v74, v21, s[32:35], s3 offen offset:128 sc1
    buffer_load_dword v75, v21, s[32:35], s3 offen offset:192 sc1
    buffer_load_dword v76, v21, s[32:35], s3 offen offset:256 sc1
    buffer_load_dword v77, v21, s[32:35], s3 offen offset:320 sc1
    buffer_load_dword v78, v21, s[32:35], s3 offen offset:384 sc1
    buffer_load_dword v79, v21, s[32:35], s3 offen offset:448 sc1
    s_sub_i32 s49, s49, 1
    s_cmp_gt_i32 s49, 0
    s_cselect_b32 s50, -2, -1
    s_waitcnt vmcnt(0)
    v_max3_u32 v4, v72, v73, v74
    v_max3_u32 v4, v4, v75, v76
    v_max3_u32 v4, v4, v77, v78
    v_max_u32 v4, v4, v79
    v_cmp_lt_u32 vcc, s50, v4
    s_cbranch_vccnz L_csu
    v_pk_add_f32 v[96:97], v[72:73], v[74:75]
    v_pk_add_f32 v[98:99], v[76:77], v[78:79]
    v_pk_add_f32 v[96:97], v[96:97], v[98:99]
    v_add_f32 v96, v96, v97
    v_mov_b32 v20, v96
    v_mov_b32 v98, 0x3b000000
    buffer_load_dword v32, v7, s[32:35], s55 offen sc1
    buffer_load_dwordx4 v[24:27], v8, s[32:35], s54 offen sc1
    buffer_load_dwordx4 v[28:31], v8, s[32:35], s54 offen offset:1024 sc1
    s_nop 11
    buffer_load_dword v42, v7, s[32:35], s55 offen sc1
    buffer_load_dwordx4 v[34:37], v8, s[32:35], s54 offen sc1
    buffer_load_dwordx4 v[38:41], v8, s[32:35], s54 offen offset:1024 sc1
    s_nop 11
    buffer_load_dword v52, v7, s[32:35], s55 offen sc1
    buffer_load_dwordx4 v[44:47], v8, s[32:35], s54 offen sc1
    buffer_load_dwordx4 v[48:51], v8, s[32:35], s54 offen offset:1024 sc1
    s_branch L_p2u0_0
L_pad18:
    s_setpc_b64 s[12:13]
L_p2u0_f2:
    buffer_load_dword v52, v7, s[32:35], s55 offen sc1
    buffer_load_dwordx4 v[44:47], v8, s[32:35], s54 offen sc1
    buffer_load_dwordx4 v[48:51], v8, s[32:35], s54 offen offset:1024 sc1
    s_sub_i32 s49, s49, 1
    s_cmp_gt_i32 s49, 0
    s_cselect_b32 s58, 0, -1
L_p2u0_0:
    s_waitcnt vmcnt(6)
    v_bitop3_b32 v4, v24, v28, s62 bitop3:0x7e
    v_cmp_eq_u32 s[16:17], -1, v32
    v_and_b32 v4, 0xff, v4
    v_add_f32_dpp v96, v32, v32 row_ror:2 row_mask:0xf bank_mask:0xf
    v_cndmask_b32 v4, v4, -1, s[16:17]
    v_cmp_lt_u32 vcc, s58, v4
    v_add_f32_dpp v96, v96, v96 row_ror:4 row_mask:0xf bank_mask:0xf
    s_cbranch_vccnz L_p2u0_f0
    v_pk_add_f32 v[88:89], v[24:25], v[28:29]
    v_pk_add_f32 v[90:91], v[26:27], v[30:31]
    v_add_f32_dpp v96, v96, v96 row_ror:8 row_mask:0xf bank_mask:0xf
    v_mov_b32 v99, 0x3727c5ac
    v_permlane32_swap_b32 v88, v90
    v_permlane32_swap_b32 v89, v91
    v_pk_add_f32 v[88:89], v[88:89], v[90:91]
    v_mul_f32_dpp v97, v96, v98 quad_perm:[1,1,3,3] row_mask:0xf bank_mask:0xf
    v_fmac_f32_dpp v99, v96, v98 quad_perm:[0,0,2,2] row_mask:0xf bank_mask:0xf
    v_permlane16_swap_b32 v88, v89
    v_add_f32 v88, v88, v89
    v_fma_f32 v99, -v97, v97, v99
    v_max_f32 v99, 0x3727c5ac, v99
    v_rsq_f32 v99, v99
    v_fma_f32 v88, -v97, v20, v88
    v_mul_f32 v88, v88, v99
    v_mul_f32 v89, 0xbfb8aa3b, v88
    v_exp_f32 v89, v89
    v_mul_f32_dpp v88, v88, v88 row_ror:8 row_mask:0xf bank_mask:0xf
    v_add_f32 v89, 1.0, v89
    v_rcp_f32 v89, v89
    s_nop 0
    v_mul_f32 v88, v88, v89
    v_cvt_pk_bf16_f32 v88, v88, v88
    buffer_store_short v88, v15, s[36:39], s41 offen
    s_branch L_p2u0_done
L_p2u0_f0:
    buffer_load_dword v32, v7, s[32:35], s55 offen sc1
    buffer_load_dwordx4 v[24:27], v8, s[32:35], s54 offen sc1
    buffer_load_dwordx4 v[28:31], v8, s[32:35], s54 offen offset:1024 sc1
L_p2u0_1:
    s_waitcnt vmcnt(6)
    v_bitop3_b32 v4, v34, v38, s62 bitop3:0x7e
    v_cmp_eq_u32 s[16:17], -1, v42
    v_and_b32 v4, 0xff, v4
    v_add_f32_dpp v96, v42, v42 row_ror:2 row_mask:0xf bank_mask:0xf
    v_cndmask_b32 v4, v4, -1, s[16:17]
    v_cmp_lt_u32 vcc, s58, v4
    v_add_f32_dpp v96, v96, v96 row_ror:4 row_mask:0xf bank_mask:0xf
    s_cbranch_vccnz L_p2u0_f1
    v_pk_add_f32 v[88:89], v[34:35], v[38:39]
    v_pk_add_f32 v[90:91], v[36:37], v[40:41]
    v_add_f32_dpp v96, v96, v96 row_ror:8 row_mask:0xf bank_mask:0xf
    v_mov_b32 v99, 0x3727c5ac
    v_permlane32_swap_b32 v88, v90
    v_permlane32_swap_b32 v89, v91
    v_pk_add_f32 v[88:89], v[88:89], v[90:91]
    v_mul_f32_dpp v97, v96, v98 quad_perm:[1,1,3,3] row_mask:0xf bank_mask:0xf
    v_fmac_f32_dpp v99, v96, v98 quad_perm:[0,0,2,2] row_mask:0xf bank_mask:0xf
    v_permlane16_swap_b32 v88, v89
    v_add_f32 v88, v88, v89
    v_fma_f32 v99, -v97, v97, v99
    v_max_f32 v99, 0x3727c5ac, v99
    v_rsq_f32 v99, v99
    v_fma_f32 v88, -v97, v20, v88
    v_mul_f32 v88, v88, v99
    v_mul_f32 v89, 0xbfb8aa3b, v88
    v_exp_f32 v89, v89
    v_mul_f32_dpp v88, v88, v88 row_ror:8 row_mask:0xf bank_mask:0xf
    v_add_f32 v89, 1.0, v89
    v_rcp_f32 v89, v89
    s_nop 0
    v_mul_f32 v88, v88, v89
    v_cvt_pk_bf16_f32 v88, v88, v88
    buffer_store_short v88, v15, s[36:39], s41 offen
    s_branch L_p2u0_done
L_pad19:
    s_setpc_b64 s[12:13]
L_p2u0_f1:
    buffer_load_dword v42, v7, s[32:35], s55 offen sc1
    buffer_load_dwordx4 v[34:37], v8, s[32:35], s54 offen sc1
    buffer_load_dwordx4 v[38:41], v8, s[32:35], s54 offen offset:1024 sc1
L_p2u0_2:
    s_waitcnt vmcnt(6)
    v_bitop3_b32 v4, v44, v48, s62 bitop3:0x7e
    v_cmp_eq_u32 s[16:17], -1, v52
    v_and_b32 v4, 0xff, v4
    v_add_f32_dpp v96, v52, v52 row_ror:2 row_mask:0xf bank_mask:0xf
    v_cndmask_b32 v4, v4, -1, s[16:17]
    v_cmp_lt_u32 vcc, s58, v4
    v_add_f32_dpp v96, v96, v96 row_ror:4 row_mask:0xf bank_mask:0xf
    s_cbranch_vccnz L_p2u0_f2
    v_pk_add_f32 v[88:89], v[44:45], v[48:49]
    v_pk_add_f32 v[90:91], v[46:47], v[50:51]
    v_add_f32_dpp v96, v96, v96 row_ror:8 row_mask:0xf bank_mask:0xf
    v_mov_b32 v99, 0x3727c5ac
    v_permlane32_swap_b32 v88, v90
    v_permlane32_swap_b32 v89, v91
    v_pk_add_f32 v[88:89], v[88:89], v[90:91]
    v_mul_f32_dpp v97, v96, v98 quad_perm:[1,1,3,3] row_mask:0xf bank_mask:0xf
    v_fmac_f32_dpp v99, v96, v98 quad_perm:[0,0,2,2] row_mask:0xf bank_mask:0xf
    v_permlane16_swap_b32 v88, v89
    v_add_f32 v88, v88, v89
    v_fma_f32 v99, -v97, v97, v99
    v_max_f32 v99, 0x3727c5ac, v99
    v_rsq_f32 v99, v99
    v_fma_f32 v88, -v97, v20, v88
    v_mul_f32 v88, v88, v99
    v_mul_f32 v89, 0xbfb8aa3b, v88
    v_exp_f32 v89, v89
    v_mul_f32_dpp v88, v88, v88 row_ror:8 row_mask:0xf bank_mask:0xf
    v_add_f32 v89, 1.0, v89
    v_rcp_f32 v89, v89
    s_nop 0
    v_mul_f32 v88, v88, v89
    v_cvt_pk_bf16_f32 v88, v88, v88
    buffer_store_short v88, v15, s[36:39], s41 offen
L_p2u0_done:
    s_cmp_lg_u32 s40, 0
    s_cbranch_scc1 L_stub9
L_stub9_r:
    v_lshlrev_b32 v117, 3, v1
    v_add_u32 v117, 131072, v117
    ds_read_b64_tr_b16 a[0:1], v117 offset:0
    ds_read_b64_tr_b16 a[2:3], v117 offset:512
    ds_read_b64_tr_b16 a[4:5], v117 offset:1024
    ds_read_b64_tr_b16 a[6:7], v117 offset:1536
    ds_read_b64_tr_b16 a[8:9], v117 offset:2048
    ds_read_b64_tr_b16 a[10:11], v117 offset:2560
    ds_read_b64_tr_b16 a[12:13], v117 offset:3072
    ds_read_b64_tr_b16 a[14:15], v117 offset:3584
    ds_read_b64_tr_b16 a[16:17], v117 offset:4096
    ds_read_b64_tr_b16 a[18:19], v117 offset:4608
    ds_read_b64_tr_b16 a[20:21], v117 offset:5120
    ds_read_b64_tr_b16 a[22:23], v117 offset:5632
    ds_read_b64_tr_b16 a[24:25], v117 offset:6144
    ds_read_b64_tr_b16 a[26:27], v117 offset:6656
    ds_read_b64_tr_b16 a[28:29], v117 offset:7168
    ds_read_b64_tr_b16 a[30:31], v117 offset:7680
    buffer_load_dwordx4 v[64:67], v8, s[32:35], s42 offen offset:0 sc1
    buffer_load_dwordx4 v[68:71], v8, s[32:35], s42 offen offset:1024 sc1
    s_nop 15
    s_nop 3
    buffer_load_dwordx4 v[72:75], v8, s[32:35], s42 offen offset:0 sc1
    buffer_load_dwordx4 v[76:79], v8, s[32:35], s42 offen offset:1024 sc1
    s_nop 15
    s_nop 3
    buffer_load_dwordx4 v[80:83], v8, s[32:35], s42 offen offset:0 sc1
    buffer_load_dwordx4 v[84:87], v8, s[32:35], s42 offen offset:1024 sc1
    s_branch L_dp0_0
L_pad20:
    s_setpc_b64 s[12:13]
L_dp0_f2:
    buffer_load_dwordx4 v[80:83], v8, s[32:35], s42 offen offset:0 sc1
    buffer_load_dwordx4 v[84:87], v8, s[32:35], s42 offen offset:1024 sc1
    s_sub_i32 s49, s49, 1
    s_cmp_gt_i32 s49, 0
    s_cselect_b32 s50, -2, -1
L_dp0_0:
    s_waitcnt vmcnt(4) lgkmcnt(0)
    v_mfma_f32_16x16x32_bf16 v[88:91], v[64:67], a[0:3], 0
    v_max3_u32 v4, v64, v65, v66
    v_max3_u32 v4, v4, v67, v68
    v_max3_u32 v4, v4, v69, v70
    v_mfma_f32_16x16x32_bf16 v[88:91], v[68:71], a[16:19], v[88:91]
    v_max_u32 v4, v4, v71
    v_cmp_lt_u32 vcc, s50, v4
    s_cbranch_vccnz L_dp0_f0
    v_mfma_f32_16x16x32_bf16 v[92:95], v[64:67], a[4:7], 0
    v_mfma_f32_16x16x32_bf16 v[92:95], v[68:71], a[20:23], v[92:95]
    s_nop 1
    v_mfma_f32_16x16x32_bf16 v[96:99], v[64:67], a[8:11], 0
    s_nop 1
    v_mfma_f32_16x16x32_bf16 v[96:99], v[68:71], a[24:27], v[96:99]
    s_nop 1
    v_mfma_f32_16x16x32_bf16 v[100:103], v[64:67], a[12:15], 0
    v_mov_b32_dpp v88, v92 quad_perm:[0,1,2,3] row_mask:0x2 bank_mask:0xf
    v_mov_b32_dpp v89, v93 quad_perm:[0,1,2,3] row_mask:0x2 bank_mask:0xf
    v_mov_b32_dpp v90, v94 quad_perm:[0,1,2,3] row_mask:0x2 bank_mask:0xf
    v_mfma_f32_16x16x32_bf16 v[100:103], v[68:71], a[28:31], v[100:103]
    v_mov_b32_dpp v91, v95 quad_perm:[0,1,2,3] row_mask:0x2 bank_mask:0xf
    s_nop 0
    v_mov_b32_dpp v88, v96 quad_perm:[0,1,2,3] row_mask:0x4 bank_mask:0xf
    v_mov_b32_dpp v89, v97 quad_perm:[0,1,2,3] row_mask:0x4 bank_mask:0xf
    v_mov_b32_dpp v90, v98 quad_perm:[0,1,2,3] row_mask:0x4 bank_mask:0xf
    v_mov_b32_dpp v91, v99 quad_perm:[0,1,2,3] row_mask:0x4 bank_mask:0xf
    s_nop 1
    v_mov_b32_dpp v88, v100 quad_perm:[0,1,2,3] row_mask:0x8 bank_mask:0xf
    v_mov_b32_dpp v89, v101 quad_perm:[0,1,2,3] row_mask:0x8 bank_mask:0xf
    v_mov_b32_dpp v90, v102 quad_perm:[0,1,2,3] row_mask:0x8 bank_mask:0xf
    v_mov_b32_dpp v91, v103 quad_perm:[0,1,2,3] row_mask:0x8 bank_mask:0xf
    s_nop 0
    v_permlane32_swap_b32 v88, v90
    v_permlane32_swap_b32 v89, v91
    v_pk_add_f32 v[88:89], v[88:89], v[90:91]
    s_nop 1
    v_permlane16_swap_b32 v88, v89
    v_add_f32 v88, v88, v89
    v_bfi_b32 v88, v10, s56, v88
    buffer_store_dword v88, v7, s[32:35], s61 offen sc1
    s_branch L_dp0_done
L_dp0_f0:
    buffer_load_dwordx4 v[64:67], v8, s[32:35], s42 offen offset:0 sc1
    buffer_load_dwordx4 v[68:71], v8, s[32:35], s42 offen offset:1024 sc1
L_dp0_1:
    s_waitcnt vmcnt(4) lgkmcnt(0)
    v_mfma_f32_16x16x32_bf16 v[88:91], v[72:75], a[0:3], 0
    v_max3_u32 v4, v72, v73, v74
    v_max3_u32 v4, v4, v75, v76
    v_max3_u32 v4, v4, v77, v78
    v_mfma_f32_16x16x32_bf16 v[88:91], v[76:79], a[16:19], v[88:91]
    v_max_u32 v4, v4, v79
    v_cmp_lt_u32 vcc, s50, v4
    s_cbranch_vccnz L_dp0_f1
    v_mfma_f32_16x16x32_bf16 v[92:95], v[72:75], a[4:7], 0
    v_mfma_f32_16x16x32_bf16 v[92:95], v[76:79], a[20:23], v[92:95]
    s_nop 1
    v_mfma_f32_16x16x32_bf16 v[96:99], v[72:75], a[8:11], 0
    s_nop 1
    v_mfma_f32_16x16x32_bf16 v[96:99], v[76:79], a[24:27], v[96:99]
    s_nop 1
    v_mfma_f32_16x16x32_bf16 v[100:103], v[72:75], a[12:15], 0
    v_mov_b32_dpp v88, v92 quad_perm:[0,1,2,3] row_mask:0x2 bank_mask:0xf
    v_mov_b32_dpp v89, v93 quad_perm:[0,1,2,3] row_mask:0x2 bank_mask:0xf
    v_mov_b32_dpp v90, v94 quad_perm:[0,1,2,3] row_mask:0x2 bank_mask:0xf
    v_mfma_f32_16x16x32_bf16 v[100:103], v[76:79], a[28:31], v[100:103]
    v_mov_b32_dpp v91, v95 quad_perm:[0,1,2,3] row_mask:0x2 bank_mask:0xf
    s_nop 0
    v_mov_b32_dpp v88, v96 quad_perm:[0,1,2,3] row_mask:0x4 bank_mask:0xf
    v_mov_b32_dpp v89, v97 quad_perm:[0,1,2,3] row_mask:0x4 bank_mask:0xf
    v_mov_b32_dpp v90, v98 quad_perm:[0,1,2,3] row_mask:0x4 bank_mask:0xf
    v_mov_b32_dpp v91, v99 quad_perm:[0,1,2,3] row_mask:0x4 bank_mask:0xf
    s_nop 1
    v_mov_b32_dpp v88, v100 quad_perm:[0,1,2,3] row_mask:0x8 bank_mask:0xf
    v_mov_b32_dpp v89, v101 quad_perm:[0,1,2,3] row_mask:0x8 bank_mask:0xf
    v_mov_b32_dpp v90, v102 quad_perm:[0,1,2,3] row_mask:0x8 bank_mask:0xf
    v_mov_b32_dpp v91, v103 quad_perm:[0,1,2,3] row_mask:0x8 bank_mask:0xf
    s_nop 0
    v_permlane32_swap_b32 v88, v90
    v_permlane32_swap_b32 v89, v91
    v_pk_add_f32 v[88:89], v[88:89], v[90:91]
    s_nop 1
    v_permlane16_swap_b32 v88, v89
    v_add_f32 v88, v88, v89
    v_bfi_b32 v88, v10, s56, v88
    buffer_store_dword v88, v7, s[32:35], s61 offen sc1
    s_branch L_dp0_done
.p2align 12
L_pad21:
    s_setpc_b64 s[12:13]
L_dp0_f1:
    buffer_load_dwordx4 v[72:75], v8, s[32:35], s42 offen offset:0 sc1
    buffer_load_dwordx4 v[76:79], v8, s[32:35], s42 offen offset:1024 sc1
L_dp0_2:
    s_waitcnt vmcnt(4) lgkmcnt(0)
    v_mfma_f32_16x16x32_bf16 v[88:91], v[80:83], a[0:3], 0
    v_max3_u32 v4, v80, v81, v82
    v_max3_u32 v4, v4, v83, v84
    v_max3_u32 v4, v4, v85, v86
    v_mfma_f32_16x16x32_bf16 v[88:91], v[84:87], a[16:19], v[88:91]
    v_max_u32 v4, v4, v87
    v_cmp_lt_u32 vcc, s50, v4
    s_cbranch_vccnz L_dp0_f2
    v_mfma_f32_16x16x32_bf16 v[92:95], v[80:83], a[4:7], 0
    v_mfma_f32_16x16x32_bf16 v[92:95], v[84:87], a[20:23], v[92:95]
    s_nop 1
    v_mfma_f32_16x16x32_bf16 v[96:99], v[80:83], a[8:11], 0
    s_nop 1
    v_mfma_f32_16x16x32_bf16 v[96:99], v[84:87], a[24:27], v[96:99]
    s_nop 1
    v_mfma_f32_16x16x32_bf16 v[100:103], v[80:83], a[12:15], 0
    v_mov_b32_dpp v88, v92 quad_perm:[0,1,2,3] row_mask:0x2 bank_mask:0xf
    v_mov_b32_dpp v89, v93 quad_perm:[0,1,2,3] row_mask:0x2 bank_mask:0xf
    v_mov_b32_dpp v90, v94 quad_perm:[0,1,2,3] row_mask:0x2 bank_mask:0xf
    v_mfma_f32_16x16x32_bf16 v[100:103], v[84:87], a[28:31], v[100:103]
    v_mov_b32_dpp v91, v95 quad_perm:[0,1,2,3] row_mask:0x2 bank_mask:0xf
    s_nop 0
    v_mov_b32_dpp v88, v96 quad_perm:[0,1,2,3] row_mask:0x4 bank_mask:0xf
    v_mov_b32_dpp v89, v97 quad_perm:[0,1,2,3] row_mask:0x4 bank_mask:0xf
    v_mov_b32_dpp v90, v98 quad_perm:[0,1,2,3] row_mask:0x4 bank_mask:0xf
    v_mov_b32_dpp v91, v99 quad_perm:[0,1,2,3] row_mask:0x4 bank_mask:0xf
    s_nop 1
    v_mov_b32_dpp v88, v100 quad_perm:[0,1,2,3] row_mask:0x8 bank_mask:0xf
    v_mov_b32_dpp v89, v101 quad_perm:[0,1,2,3] row_mask:0x8 bank_mask:0xf
    v_mov_b32_dpp v90, v102 quad_perm:[0,1,2,3] row_mask:0x8 bank_mask:0xf
    v_mov_b32_dpp v91, v103 quad_perm:[0,1,2,3] row_mask:0x8 bank_mask:0xf
    s_nop 0
    v_permlane32_swap_b32 v88, v90
    v_permlane32_swap_b32 v89, v91
    v_pk_add_f32 v[88:89], v[88:89], v[90:91]
    s_nop 1
    v_permlane16_swap_b32 v88, v89
    v_add_f32 v88, v88, v89
    v_bfi_b32 v88, v10, s56, v88
    buffer_store_dword v88, v7, s[32:35], s61 offen sc1
L_dp0_done:
    s_xor_b32 s61, s61, 8192
    buffer_store_dword v88, v7, s[32:35], s61 offen sc1
    s_barrier
L_c_skip0:
    s_lshl_b32 s3, s46, 9
    s_add_u32 s3, s3, s51
    s_add_u32 s3, s3, 90112
L_csq:
    buffer_load_dword v72, v21, s[32:35], s3 offen offset:0 sc1
    buffer_load_dword v73, v21, s[32:35], s3 offen offset:64 sc1
    buffer_load_dword v74, v21, s[32:35], s3 offen offset:128 sc1
    buffer_load_dword v75, v21, s[32:35], s3 offen offset:192 sc1
    buffer_load_dword v76, v21, s[32:35], s3 offen offset:256 sc1
    buffer_load_dword v77, v21, s[32:35], s3 offen offset:320 sc1
    buffer_load_dword v78, v21, s[32:35], s3 offen offset:384 sc1
    buffer_load_dword v79, v21, s[32:35], s3 offen offset:448 sc1
    s_sub_i32 s49, s49, 1
    s_cmp_gt_i32 s49, 0
    s_cselect_b32 s50, -2, -1
    s_waitcnt vmcnt(0)
    v_max3_u32 v4, v72, v73, v74
    v_max3_u32 v4, v4, v75, v76
    v_max3_u32 v4, v4, v77, v78
    v_max_u32 v4, v4, v79
    v_cmp_lt_u32 vcc, s50, v4
    s_cbranch_vccnz L_csq
    v_pk_add_f32 v[96:97], v[72:73], v[74:75]
    v_pk_add_f32 v[98:99], v[76:77], v[78:79]
    v_pk_add_f32 v[96:97], v[96:97], v[98:99]
    v_add_f32 v96, v96, v97
    v_mov_b32 v19, v96
    s_branch L_over22
L_pad22:
    s_setpc_b64 s[12:13]
L_over22:
    s_add_u32 s62, s56, 2
    s_lshl_b32 s3, s52, 5
    s_add_u32 s3, s3, s53
    s_lshl3_add_u32 s3, s3, s51
    s_add_u32 s3, s3, 53248
    s_lshl_b32 s54, s46, 11
    s_add_u32 s54, s54, s51
    s_add_u32 s54, s54, 114688
    s_lshl_b32 s55, s47, 8
    s_add_u32 s55, s55, s51
    s_add_u32 s55, s55, 53248
    s_and_b32 s41, s46, 1
    s_lshl_b32 s41, s41, 9
    s_lshr_b32 s61, s48, 1
    s_lshl2_add_u32 s61, s61, s47
    s_lshl4_add_u32 s41, s61, s41
    s_add_u32 s41, s41, s51
    s_add_u32 s41, s41, 109568
    s_barrier
    ds_read_b128 v[88:91], v12 offset:0
    ds_read_b128 v[92:95], v12 offset:256
    s_waitcnt lgkmcnt(1)
    v_mfma_f32_16x16x32_bf16 v[116:119], v[88:91], v[88:91], 0
    s_waitcnt lgkmcnt(0)
    v_mfma_f32_16x16x32_bf16 v[116:119], v[92:95], v[92:95], v[116:119]
    s_nop 7
    v_cndmask_b32 v116, v116, v117, s[10:11]
    v_cndmask_b32 v116, v116, v118, s[12:13]
    v_cndmask_b32 v116, v116, v119, s[14:15]
    buffer_store_dword v116, v18, s[36:39], s3 offen
    s_cmp_lg_u32 s40, 0
    s_cbranch_scc1 L_stub10
L_stub10_r:
    v_mov_b32 v98, 0x3b000000
    s_nop 15
    s_nop 15
    s_nop 3
    buffer_load_dword v32, v7, s[32:35], s55 offen sc1
    buffer_load_dwordx4 v[24:27], v8, s[32:35], s54 offen sc1
    buffer_load_dwordx4 v[28:31], v8, s[32:35], s54 offen offset:1024 sc1
    s_nop 11
    buffer_load_dword v42, v7, s[32:35], s55 offen sc1
    buffer_load_dwordx4 v[34:37], v8, s[32:35], s54 offen sc1
    buffer_load_dwordx4 v[38:41], v8, s[32:35], s54 offen offset:1024 sc1
    s_nop 11
    buffer_load_dword v52, v7, s[32:35], s55 offen sc1
    buffer_load_dwordx4 v[44:47], v8, s[32:35], s54 offen sc1
    buffer_load_dwordx4 v[48:51], v8, s[32:35], s54 offen offset:1024 sc1
    s_branch L_p2q1_0
L_p2q1_f2:
    buffer_load_dword v52, v7, s[32:35], s55 offen sc1
    buffer_load_dwordx4 v[44:47], v8, s[32:35], s54 offen sc1
    buffer_load_dwordx4 v[48:51], v8, s[32:35], s54 offen offset:1024 sc1
    s_sub_i32 s49, s49, 1
    s_cmp_gt_i32 s49, 0
    s_cselect_b32 s58, 0, -1
L_p2q1_0:
    s_waitcnt vmcnt(6)
    v_bitop3_b32 v4, v24, v28, s62 bitop3:0x7e
    v_cmp_eq_u32 s[16:17], -1, v32
    v_and_b32 v4, 0xff, v4
    v_add_f32_dpp v96, v32, v32 row_ror:2 row_mask:0xf bank_mask:0xf
    v_cndmask_b32 v4, v4, -1, s[16:17]
    v_cmp_lt_u32 vcc, s58, v4
    v_add_f32_dpp v96, v96, v96 row_ror:4 row_mask:0xf bank_mask:0xf
    s_cbranch_vccnz L_p2q1_f0
    v_pk_add_f32 v[88:89], v[24:25], v[28:29]
    v_pk_add_f32 v[90:91], v[26:27], v[30:31]
    v_add_f32_dpp v96, v96, v96 row_ror:8 row_mask:0xf bank_mask:0xf
    v_mov_b32 v99, 0x3727c5ac
    v_permlane32_swap_b32 v88, v90
    v_permlane32_swap_b32 v89, v91
    v_pk_add_f32 v[88:89], v[88:89], v[90:91]
    v_mul_f32_dpp v97, v96, v98 quad_perm:[1,1,3,3] row_mask:0xf bank_mask:0xf
    v_fmac_f32_dpp v99, v96, v98 quad_perm:[0,0,2,2] row_mask:0xf bank_mask:0xf
    v_permlane16_swap_b32 v88, v89
    v_add_f32 v88, v88, v89
    v_fma_f32 v99, -v97, v97, v99
    v_max_f32 v99, 0x3727c5ac, v99
    v_rsq_f32 v99, v99
    v_fma_f32 v88, -v97, v19, v88
    v_mul_f32 v88, 0x3e0293ee, v88
    v_mul_f32 v88, v88, v99
    v_cvt_pk_bf16_f32 v88, v88, v88
    buffer_store_short v88, v14, s[36:39], s41 offen
    s_branch L_p2q1_done
L_pad23:
    s_setpc_b64 s[12:13]
L_p2q1_f0:
    buffer_load_dword v32, v7, s[32:35], s55 offen sc1
    buffer_load_dwordx4 v[24:27], v8, s[32:35], s54 offen sc1
    buffer_load_dwordx4 v[28:31], v8, s[32:35], s54 offen offset:1024 sc1
L_p2q1_1:
    s_waitcnt vmcnt(6)
    v_bitop3_b32 v4, v34, v38, s62 bitop3:0x7e
    v_cmp_eq_u32 s[16:17], -1, v42
    v_and_b32 v4, 0xff, v4
    v_add_f32_dpp v96, v42, v42 row_ror:2 row_mask:0xf bank_mask:0xf
    v_cndmask_b32 v4, v4, -1, s[16:17]
    v_cmp_lt_u32 vcc, s58, v4
    v_add_f32_dpp v96, v96, v96 row_ror:4 row_mask:0xf bank_mask:0xf
    s_cbranch_vccnz L_p2q1_f1
    v_pk_add_f32 v[88:89], v[34:35], v[38:39]
    v_pk_add_f32 v[90:91], v[36:37], v[40:41]
    v_add_f32_dpp v96, v96, v96 row_ror:8 row_mask:0xf bank_mask:0xf
    v_mov_b32 v99, 0x3727c5ac
    v_permlane32_swap_b32 v88, v90
    v_permlane32_swap_b32 v89, v91
    v_pk_add_f32 v[88:89], v[88:89], v[90:91]
    v_mul_f32_dpp v97, v96, v98 quad_perm:[1,1,3,3] row_mask:0xf bank_mask:0xf
    v_fmac_f32_dpp v99, v96, v98 quad_perm:[0,0,2,2] row_mask:0xf bank_mask:0xf
    v_permlane16_swap_b32 v88, v89
    v_add_f32 v88, v88, v89
    v_fma_f32 v99, -v97, v97, v99
    v_max_f32 v99, 0x3727c5ac, v99
    v_rsq_f32 v99, v99
    v_fma_f32 v88, -v97, v19, v88
    v_mul_f32 v88, 0x3e0293ee, v88
    v_mul_f32 v88, v88, v99
    v_cvt_pk_bf16_f32 v88, v88, v88
    buffer_store_short v88, v14, s[36:39], s41 offen
    s_branch L_p2q1_done
L_p2q1_f1:
    buffer_load_dword v42, v7, s[32:35], s55 offen sc1
    buffer_load_dwordx4 v[34:37], v8, s[32:35], s54 offen sc1
    buffer_load_dwordx4 v[38:41], v8, s[32:35], s54 offen offset:1024 sc1
L_p2q1_2:
    s_waitcnt vmcnt(6)
    v_bitop3_b32 v4, v44, v48, s62 bitop3:0x7e
    v_cmp_eq_u32 s[16:17], -1, v52
    v_and_b32 v4, 0xff, v4
    v_add_f32_dpp v96, v52, v52 row_ror:2 row_mask:0xf bank_mask:0xf
    v_cndmask_b32 v4, v4, -1, s[16:17]
    v_cmp_lt_u32 vcc, s58, v4
    v_add_f32_dpp v96, v96, v96 row_ror:4 row_mask:0xf bank_mask:0xf
    s_cbranch_vccnz L_p2q1_f2
    v_pk_add_f32 v[88:89], v[44:45], v[48:49]
    v_pk_add_f32 v[90:91], v[46:47], v[50:51]
    v_add_f32_dpp v96, v96, v96 row_ror:8 row_mask:0xf bank_mask:0xf
    v_mov_b32 v99, 0x3727c5ac
    v_permlane32_swap_b32 v88, v90
    v_permlane32_swap_b32 v89, v91
    v_pk_add_f32 v[88:89], v[88:89], v[90:91]
    v_mul_f32_dpp v97, v96, v98 quad_perm:[1,1,3,3] row_mask:0xf bank_mask:0xf
    v_fmac_f32_dpp v99, v96, v98 quad_perm:[0,0,2,2] row_mask:0xf bank_mask:0xf
    v_permlane16_swap_b32 v88, v89
    v_add_f32 v88, v88, v89
    v_fma_f32 v99, -v97, v97, v99
    v_max_f32 v99, 0x3727c5ac, v99
    v_rsq_f32 v99, v99
    v_fma_f32 v88, -v97, v19, v88
    v_mul_f32 v88, 0x3e0293ee, v88
    v_mul_f32 v88, v88, v99
    v_cvt_pk_bf16_f32 v88, v88, v88
    buffer_store_short v88, v14, s[36:39], s41 offen
L_p2q1_done:
    s_cmp_lg_u32 s40, 0
    s_cbranch_scc1 L_stub11
L_stub11_r:
    s_barrier
    v_lshlrev_b32 v6, 3, v3
    v_lshl_add_u32 v6, v2, 8, v6
    s_and_b32 s41, s46, 1
    s_lshl_b32 s41, s41, 7
    s_add_u32 s41, s41, s51
    s_add_u32 s41, s41, 108544
    v_and_b32 v4, 48, v8
    v_add_u32 v4, 147712, v4
    v_lshlrev_b32 v5, 8, v1
    v_cmp_gt_u32 vcc, 4, v1
    s_nop 1
    v_cndmask_b32 v5, v11, v5, vcc
    s_lshl3_add_u32 s42, s46, s51
    s_add_u32 s42, s42, 108544
    s_barrier
    s_branch L_over24
L_pad24:
    s_setpc_b64 s[12:13]
L_over24:
    ds_read_b128 v[88:91], v4
    s_waitcnt lgkmcnt(0)
    v_max3_f32 v96, v88, v89, v90
    v_max_f32 v96, v96, v91
    s_barrier
    ds_read_b128 v[92:95], v4 offset:64
    s_waitcnt lgkmcnt(0)
    v_pk_add_f32 v[92:93], v[92:93], v[94:95]
    v_add_f32 v97, v92, v93
    buffer_store_dwordx2 v[96:97], v5, s[36:39], s42 offen
    s_cmp_lg_u32 s40, 0
    s_cbranch_scc1 L_stub12
L_stub12_r:
    s_add_u32 s55, s20, 0x40000
    s_add_u32 s55, s55, s43
    s_xor_b32 s54, s55, 8192
    s_nop 15
    s_nop 15
    s_nop 15
    s_nop 7
    buffer_load_dwordx2 v[24:25], v6, s[32:35], s41 offen sc1
    s_nop 13
    buffer_load_dwordx2 v[26:27], v6, s[32:35], s41 offen sc1
    s_nop 13
    buffer_load_dwordx2 v[28:29], v6, s[32:35], s41 offen sc1
    s_branch L_cw_0
L_cw_f2:
    buffer_load_dwordx2 v[28:29], v6, s[32:35], s41 offen sc1
    s_sub_i32 s49, s49, 1
    s_cmp_gt_i32 s49, 0
    s_cselect_b32 s50, -2, -1
L_cw_0:
    s_waitcnt vmcnt(2)
    v_cmp_lt_u32 vcc, s50, v24
    v_max_f32_dpp v88, v24, v24 quad_perm:[1,0,3,2] row_mask:0xf bank_mask:0xf
    s_cbranch_vccnz L_cw_f0
    s_nop 0
    v_max_f32_dpp v88, v88, v88 quad_perm:[2,3,0,1] row_mask:0xf bank_mask:0xf
    s_nop 1
    v_max_f32_dpp v88, v88, v88 row_half_mirror row_mask:0xf bank_mask:0xf
    v_sub_f32 v89, v24, v88
    v_exp_f32 v89, v89
    s_nop 0
    v_mul_f32 v88, v89, v25
    s_nop 1
    v_add_f32_dpp v88, v88, v88 quad_perm:[1,0,3,2] row_mask:0xf bank_mask:0xf
    s_nop 1
    v_add_f32_dpp v88, v88, v88 quad_perm:[2,3,0,1] row_mask:0xf bank_mask:0xf
    s_nop 1
    v_add_f32_dpp v88, v88, v88 row_half_mirror row_mask:0xf bank_mask:0xf
    v_rcp_f32 v88, v88
    s_nop 0
    v_mul_f32 v89, v89, v88
    ds_write_b32 v22, v89
    s_branch L_cw_done
L_cw_f0:
    buffer_load_dwordx2 v[24:25], v6, s[32:35], s41 offen sc1
L_cw_1:
    s_waitcnt vmcnt(2)
    v_cmp_lt_u32 vcc, s50, v26
    v_max_f32_dpp v88, v26, v26 quad_perm:[1,0,3,2] row_mask:0xf bank_mask:0xf
    s_cbranch_vccnz L_cw_f1
    s_nop 0
    v_max_f32_dpp v88, v88, v88 quad_perm:[2,3,0,1] row_mask:0xf bank_mask:0xf
    s_nop 1
    v_max_f32_dpp v88, v88, v88 row_half_mirror row_mask:0xf bank_mask:0xf
    v_sub_f32 v89, v26, v88
    v_exp_f32 v89, v89
    s_nop 0
    v_mul_f32 v88, v89, v27
    s_nop 1
    v_add_f32_dpp v88, v88, v88 quad_perm:[1,0,3,2] row_mask:0xf bank_mask:0xf
    s_nop 1
    v_add_f32_dpp v88, v88, v88 quad_perm:[2,3,0,1] row_mask:0xf bank_mask:0xf
    s_nop 1
    v_add_f32_dpp v88, v88, v88 row_half_mirror row_mask:0xf bank_mask:0xf
    v_rcp_f32 v88, v88
    s_nop 0
    v_mul_f32 v89, v89, v88
    ds_write_b32 v22, v89
    s_branch L_cw_done
L_cw_f1:
    buffer_load_dwordx2 v[26:27], v6, s[32:35], s41 offen sc1
L_cw_2:
    s_waitcnt vmcnt(2)
    v_cmp_lt_u32 vcc, s50, v28
    v_max_f32_dpp v88, v28, v28 quad_perm:[1,0,3,2] row_mask:0xf bank_mask:0xf
    s_cbranch_vccnz L_cw_f2
    s_nop 0
    v_max_f32_dpp v88, v88, v88 quad_perm:[2,3,0,1] row_mask:0xf bank_mask:0xf
    s_nop 1
    v_max_f32_dpp v88, v88, v88 row_half_mirror row_mask:0xf bank_mask:0xf
    v_sub_f32 v89, v28, v88
    v_exp_f32 v89, v89
    s_nop 0
    v_mul_f32 v88, v89, v29
    s_nop 1
    v_add_f32_dpp v88, v88, v88 quad_perm:[1,0,3,2] row_mask:0xf bank_mask:0xf
    s_nop 1
    v_add_f32_dpp v88, v88, v88 quad_perm:[2,3,0,1] row_mask:0xf bank_mask:0xf
    s_nop 1
    v_add_f32_dpp v88, v88, v88 row_half_mirror row_mask:0xf bank_mask:0xf
    v_rcp_f32 v88, v88
    s_nop 0
    v_mul_f32 v89, v89, v88
    ds_write_b32 v22, v89
L_cw_done:
    s_barrier
    ds_read2_b32 v[88:89], v17 offset0:0 offset1:64
    ds_read2_b32 v[90:91], v17 offset0:128 offset1:192
    s_waitcnt lgkmcnt(0)
    v_pk_add_f32 v[88:89], v[88:89], v[90:91]
    v_add_f32 v88, v88, v89
    v_bfi_b32 v88, v10, s56, v88
    buffer_store_dword v88, v16, s[32:35], s54 offen offset:0 sc1
    buffer_store_dword v88, v16, s[32:35], s55 offen offset:0 sc1
    s_barrier
    s_cmp_eq_u32 s45, 7
    s_cbranch_scc1 L_c_end
    s_branch L_over25
L_pad25:
    s_setpc_b64 s[12:13]
L_over25:
    s_add_u32 s62, s56, 3
    s_lshl_b32 s3, s52, 5
    s_add_u32 s3, s3, s53
    s_lshl3_add_u32 s3, s3, s51
    s_add_u32 s3, s3, 54272
    s_lshl_b32 s54, s46, 11
    s_add_u32 s54, s54, s51
    s_add_u32 s54, s54, 114688
    s_lshl_b32 s55, s47, 8
    s_add_u32 s55, s55, s51
    s_add_u32 s55, s55, 54272
    s_lshr_b32 s41, s46, 4
    s_lshl2_add_u32 s41, s41, s52
    s_and_b32 s61, s53, 3
    s_lshl2_add_u32 s41, s41, s61
    s_lshl_b32 s41, s41, 6
    s_add_u32 s41, s41, s51
    s_add_u32 s41, s41, 106496
    s_add_u32 s42, s51, 106496
    s_add_u32 s61, s60, 0x62000
    s_sub_u32 s61, s61, s43
    s_barrier
    ds_read_b128 v[88:91], v12 offset:1536
    ds_read_b128 v[92:95], v12 offset:1792
    s_waitcnt lgkmcnt(1)
    v_mfma_f32_16x16x32_bf16 v[116:119], v[88:91], v[88:91], 0
    s_waitcnt lgkmcnt(0)
    v_mfma_f32_16x16x32_bf16 v[116:119], v[92:95], v[92:95], v[116:119]
    s_nop 7
    v_cndmask_b32 v116, v116, v117, s[10:11]
    v_cndmask_b32 v116, v116, v118, s[12:13]
    v_cndmask_b32 v116, v116, v119, s[14:15]
    buffer_store_dword v116, v18, s[36:39], s3 offen
    s_cmp_lg_u32 s40, 0
    s_cbranch_scc1 L_stub13
L_stub13_r:
    v_mov_b32 v98, 0x3b000000
    s_nop 15
    s_nop 15
    s_nop 3
    buffer_load_dword v32, v7, s[32:35], s55 offen sc1
    buffer_load_dwordx4 v[24:27], v8, s[32:35], s54 offen sc1
    buffer_load_dwordx4 v[28:31], v8, s[32:35], s54 offen offset:1024 sc1
    s_nop 11
    buffer_load_dword v42, v7, s[32:35], s55 offen sc1
    buffer_load_dwordx4 v[34:37], v8, s[32:35], s54 offen sc1
    buffer_load_dwordx4 v[38:41], v8, s[32:35], s54 offen offset:1024 sc1
    s_nop 11
    buffer_load_dword v52, v7, s[32:35], s55 offen sc1
    buffer_load_dwordx4 v[44:47], v8, s[32:35], s54 offen sc1
    buffer_load_dwordx4 v[48:51], v8, s[32:35], s54 offen offset:1024 sc1
    s_branch L_p2u1_0
L_p2u1_f2:
    buffer_load_dword v52, v7, s[32:35], s55 offen sc1
    buffer_load_dwordx4 v[44:47], v8, s[32:35], s54 offen sc1
    buffer_load_dwordx4 v[48:51], v8, s[32:35], s54 offen offset:1024 sc1
    s_sub_i32 s49, s49, 1
    s_cmp_gt_i32 s49, 0
    s_cselect_b32 s58, 0, -1
L_p2u1_0:
    s_waitcnt vmcnt(6)
    v_bitop3_b32 v4, v24, v28, s62 bitop3:0x7e
    v_cmp_eq_u32 s[16:17], -1, v32
    v_and_b32 v4, 0xff, v4
    v_add_f32_dpp v96, v32, v32 row_ror:2 row_mask:0xf bank_mask:0xf
    v_cndmask_b32 v4, v4, -1, s[16:17]
    v_cmp_lt_u32 vcc, s58, v4
    v_add_f32_dpp v96, v96, v96 row_ror:4 row_mask:0xf bank_mask:0xf
    s_cbranch_vccnz L_p2u1_f0
    v_pk_add_f32 v[88:89], v[24:25], v[28:29]
    v_pk_add_f32 v[90:91], v[26:27], v[30:31]
    v_add_f32_dpp v96, v96, v96 row_ror:8 row_mask:0xf bank_mask:0xf
    v_mov_b32 v99, 0x3727c5ac
    v_permlane32_swap_b32 v88, v90
    v_permlane32_swap_b32 v89, v91
    v_pk_add_f32 v[88:89], v[88:89], v[90:91]
    v_mul_f32_dpp v97, v96, v98 quad_perm:[1,1,3,3] row_mask:0xf bank_mask:0xf
    v_fmac_f32_dpp v99, v96, v98 quad_perm:[0,0,2,2] row_mask:0xf bank_mask:0xf
    v_permlane16_swap_b32 v88, v89
    v_add_f32 v88, v88, v89
    v_fma_f32 v99, -v97, v97, v99
    v_max_f32 v99, 0x3727c5ac, v99
    v_rsq_f32 v99, v99
    v_fma_f32 v88, -v97, v20, v88
    v_mul_f32 v88, v88, v99
    v_mul_f32 v89, 0xbfb8aa3b, v88
    v_exp_f32 v89, v89
    v_mul_f32_dpp v88, v88, v88 row_ror:8 row_mask:0xf bank_mask:0xf
    v_add_f32 v89, 1.0, v89
    v_rcp_f32 v89, v89
    s_nop 0
    v_mul_f32 v88, v88, v89
    v_cvt_pk_bf16_f32 v88, v88, v88
    buffer_store_short v88, v15, s[36:39], s41 offen
    s_branch L_p2u1_done
L_pad26:
    s_setpc_b64 s[12:13]
L_p2u1_f0:
    buffer_load_dword v32, v7, s[32:35], s55 offen sc1
    buffer_load_dwordx4 v[24:27], v8, s[32:35], s54 offen sc1
    buffer_load_dwordx4 v[28:31], v8, s[32:35], s54 offen offset:1024 sc1
L_p2u1_1:
    s_waitcnt vmcnt(6)
    v_bitop3_b32 v4, v34, v38, s62 bitop3:0x7e
    v_cmp_eq_u32 s[16:17], -1, v42
    v_and_b32 v4, 0xff, v4
    v_add_f32_dpp v96, v42, v42 row_ror:2 row_mask:0xf bank_mask:0xf
    v_cndmask_b32 v4, v4, -1, s[16:17]
    v_cmp_lt_u32 vcc, s58, v4
    v_add_f32_dpp v96, v96, v96 row_ror:4 row_mask:0xf bank_mask:0xf
    s_cbranch_vccnz L_p2u1_f1
    v_pk_add_f32 v[88:89], v[34:35], v[38:39]
    v_pk_add_f32 v[90:91], v[36:37], v[40:41]
    v_add_f32_dpp v96, v96, v96 row_ror:8 row_mask:0xf bank_mask:0xf
    v_mov_b32 v99, 0x3727c5ac
    v_permlane32_swap_b32 v88, v90
    v_permlane32_swap_b32 v89, v91
    v_pk_add_f32 v[88:89], v[88:89], v[90:91]
    v_mul_f32_dpp v97, v96, v98 quad_perm:[1,1,3,3] row_mask:0xf bank_mask:0xf
    v_fmac_f32_dpp v99, v96, v98 quad_perm:[0,0,2,2] row_mask:0xf bank_mask:0xf
    v_permlane16_swap_b32 v88, v89
    v_add_f32 v88, v88, v89
    v_fma_f32 v99, -v97, v97, v99
    v_max_f32 v99, 0x3727c5ac, v99
    v_rsq_f32 v99, v99
    v_fma_f32 v88, -v97, v20, v88
    v_mul_f32 v88, v88, v99
    v_mul_f32 v89, 0xbfb8aa3b, v88
    v_exp_f32 v89, v89
    v_mul_f32_dpp v88, v88, v88 row_ror:8 row_mask:0xf bank_mask:0xf
    v_add_f32 v89, 1.0, v89
    v_rcp_f32 v89, v89
    s_nop 0
    v_mul_f32 v88, v88, v89
    v_cvt_pk_bf16_f32 v88, v88, v88
    buffer_store_short v88, v15, s[36:39], s41 offen
    s_branch L_p2u1_done
L_p2u1_f1:
    buffer_load_dword v42, v7, s[32:35], s55 offen sc1
    buffer_load_dwordx4 v[34:37], v8, s[32:35], s54 offen sc1
    buffer_load_dwordx4 v[38:41], v8, s[32:35], s54 offen offset:1024 sc1
L_p2u1_2:
    s_waitcnt vmcnt(6)
    v_bitop3_b32 v4, v44, v48, s62 bitop3:0x7e
    v_cmp_eq_u32 s[16:17], -1, v52
    v_and_b32 v4, 0xff, v4
    v_add_f32_dpp v96, v52, v52 row_ror:2 row_mask:0xf bank_mask:0xf
    v_cndmask_b32 v4, v4, -1, s[16:17]
    v_cmp_lt_u32 vcc, s58, v4
    v_add_f32_dpp v96, v96, v96 row_ror:4 row_mask:0xf bank_mask:0xf
    s_cbranch_vccnz L_p2u1_f2
    v_pk_add_f32 v[88:89], v[44:45], v[48:49]
    v_pk_add_f32 v[90:91], v[46:47], v[50:51]
    v_add_f32_dpp v96, v96, v96 row_ror:8 row_mask:0xf bank_mask:0xf
    v_mov_b32 v99, 0x3727c5ac
    v_permlane32_swap_b32 v88, v90
    v_permlane32_swap_b32 v89, v91
    v_pk_add_f32 v[88:89], v[88:89], v[90:91]
    v_mul_f32_dpp v97, v96, v98 quad_perm:[1,1,3,3] row_mask:0xf bank_mask:0xf
    v_fmac_f32_dpp v99, v96, v98 quad_perm:[0,0,2,2] row_mask:0xf bank_mask:0xf
    v_permlane16_swap_b32 v88, v89
    v_add_f32 v88, v88, v89
    v_fma_f32 v99, -v97, v97, v99
    v_max_f32 v99, 0x3727c5ac, v99
    v_rsq_f32 v99, v99
    v_fma_f32 v88, -v97, v20, v88
    v_mul_f32 v88, v88, v99
    v_mul_f32 v89, 0xbfb8aa3b, v88
    v_exp_f32 v89, v89
    v_mul_f32_dpp v88, v88, v88 row_ror:8 row_mask:0xf bank_mask:0xf
    v_add_f32 v89, 1.0, v89
    v_rcp_f32 v89, v89
    s_nop 0
    v_mul_f32 v88, v88, v89
    v_cvt_pk_bf16_f32 v88, v88, v88
    buffer_store_short v88, v15, s[36:39], s41 offen
L_p2u1_done:
    s_cmp_lg_u32 s40, 0
    s_cbranch_scc1 L_stub14
L_stub14_r:
    buffer_load_dwordx4 v[64:67], v8, s[32:35], s42 offen offset:0 sc1
    buffer_load_dwordx4 v[68:71], v8, s[32:35], s42 offen offset:1024 sc1
    s_nop 15
    s_nop 3
    buffer_load_dwordx4 v[72:75], v8, s[32:35], s42 offen offset:0 sc1
    buffer_load_dwordx4 v[76:79], v8, s[32:35], s42 offen offset:1024 sc1
    s_nop 15
    s_nop 3
    buffer_load_dwordx4 v[80:83], v8, s[32:35], s42 offen offset:0 sc1
    buffer_load_dwordx4 v[84:87], v8, s[32:35], s42 offen offset:1024 sc1
    s_branch L_dp1_0
L_pad27:
    s_setpc_b64 s[12:13]
L_dp1_f2:
    buffer_load_dwordx4 v[80:83], v8, s[32:35], s42 offen offset:0 sc1
    buffer_load_dwordx4 v[84:87], v8, s[32:35], s42 offen offset:1024 sc1
    s_sub_i32 s49, s49, 1
    s_cmp_gt_i32 s49, 0
    s_cselect_b32 s50, -2, -1
L_dp1_0:
    s_waitcnt vmcnt(4)
    v_mfma_f32_16x16x32_bf16 v[88:91], v[64:67], a[0:3], 0
    v_max3_u32 v4, v64, v65, v66
    v_max3_u32 v4, v4, v67, v68
    v_max3_u32 v4, v4, v69, v70
    v_mfma_f32_16x16x32_bf16 v[88:91], v[68:71], a[16:19], v[88:91]
    v_max_u32 v4, v4, v71
    v_cmp_lt_u32 vcc, s50, v4
    s_cbranch_vccnz L_dp1_f0
    v_mfma_f32_16x16x32_bf16 v[92:95], v[64:67], a[4:7], 0
    v_mfma_f32_16x16x32_bf16 v[92:95], v[68:71], a[20:23], v[92:95]
    s_nop 1
    v_mfma_f32_16x16x32_bf16 v[96:99], v[64:67], a[8:11], 0
    s_nop 1
    v_mfma_f32_16x16x32_bf16 v[96:99], v[68:71], a[24:27], v[96:99]
    s_nop 1
    v_mfma_f32_16x16x32_bf16 v[100:103], v[64:67], a[12:15], 0
    v_mov_b32_dpp v88, v92 quad_perm:[0,1,2,3] row_mask:0x2 bank_mask:0xf
    v_mov_b32_dpp v89, v93 quad_perm:[0,1,2,3] row_mask:0x2 bank_mask:0xf
    v_mov_b32_dpp v90, v94 quad_perm:[0,1,2,3] row_mask:0x2 bank_mask:0xf
    v_mfma_f32_16x16x32_bf16 v[100:103], v[68:71], a[28:31], v[100:103]
    v_mov_b32_dpp v91, v95 quad_perm:[0,1,2,3] row_mask:0x2 bank_mask:0xf
    s_nop 0
    v_mov_b32_dpp v88, v96 quad_perm:[0,1,2,3] row_mask:0x4 bank_mask:0xf
    v_mov_b32_dpp v89, v97 quad_perm:[0,1,2,3] row_mask:0x4 bank_mask:0xf
    v_mov_b32_dpp v90, v98 quad_perm:[0,1,2,3] row_mask:0x4 bank_mask:0xf
    v_mov_b32_dpp v91, v99 quad_perm:[0,1,2,3] row_mask:0x4 bank_mask:0xf
    s_nop 1
    v_mov_b32_dpp v88, v100 quad_perm:[0,1,2,3] row_mask:0x8 bank_mask:0xf
    v_mov_b32_dpp v89, v101 quad_perm:[0,1,2,3] row_mask:0x8 bank_mask:0xf
    v_mov_b32_dpp v90, v102 quad_perm:[0,1,2,3] row_mask:0x8 bank_mask:0xf
    v_mov_b32_dpp v91, v103 quad_perm:[0,1,2,3] row_mask:0x8 bank_mask:0xf
    s_nop 0
    v_permlane32_swap_b32 v88, v90
    v_permlane32_swap_b32 v89, v91
    v_pk_add_f32 v[88:89], v[88:89], v[90:91]
    s_nop 1
    v_permlane16_swap_b32 v88, v89
    v_add_f32 v88, v88, v89
    v_bfi_b32 v88, v10, s56, v88
    buffer_store_dword v88, v7, s[32:35], s61 offen sc1
    s_branch L_dp1_done
L_dp1_f0:
    buffer_load_dwordx4 v[64:67], v8, s[32:35], s42 offen offset:0 sc1
    buffer_load_dwordx4 v[68:71], v8, s[32:35], s42 offen offset:1024 sc1
L_dp1_1:
    s_waitcnt vmcnt(4)
    v_mfma_f32_16x16x32_bf16 v[88:91], v[72:75], a[0:3], 0
    v_max3_u32 v4, v72, v73, v74
    v_max3_u32 v4, v4, v75, v76
    v_max3_u32 v4, v4, v77, v78
    v_mfma_f32_16x16x32_bf16 v[88:91], v[76:79], a[16:19], v[88:91]
    v_max_u32 v4, v4, v79
    v_cmp_lt_u32 vcc, s50, v4
    s_cbranch_vccnz L_dp1_f1
    v_mfma_f32_16x16x32_bf16 v[92:95], v[72:75], a[4:7], 0
    v_mfma_f32_16x16x32_bf16 v[92:95], v[76:79], a[20:23], v[92:95]
    s_nop 1
    v_mfma_f32_16x16x32_bf16 v[96:99], v[72:75], a[8:11], 0
    s_nop 1
    v_mfma_f32_16x16x32_bf16 v[96:99], v[76:79], a[24:27], v[96:99]
    s_nop 1
    v_mfma_f32_16x16x32_bf16 v[100:103], v[72:75], a[12:15], 0
    v_mov_b32_dpp v88, v92 quad_perm:[0,1,2,3] row_mask:0x2 bank_mask:0xf
    v_mov_b32_dpp v89, v93 quad_perm:[0,1,2,3] row_mask:0x2 bank_mask:0xf
    v_mov_b32_dpp v90, v94 quad_perm:[0,1,2,3] row_mask:0x2 bank_mask:0xf
    v_mfma_f32_16x16x32_bf16 v[100:103], v[76:79], a[28:31], v[100:103]
    v_mov_b32_dpp v91, v95 quad_perm:[0,1,2,3] row_mask:0x2 bank_mask:0xf
    s_nop 0
    v_mov_b32_dpp v88, v96 quad_perm:[0,1,2,3] row_mask:0x4 bank_mask:0xf
    v_mov_b32_dpp v89, v97 quad_perm:[0,1,2,3] row_mask:0x4 bank_mask:0xf
    v_mov_b32_dpp v90, v98 quad_perm:[0,1,2,3] row_mask:0x4 bank_mask:0xf
    v_mov_b32_dpp v91, v99 quad_perm:[0,1,2,3] row_mask:0x4 bank_mask:0xf
    s_nop 1
    v_mov_b32_dpp v88, v100 quad_perm:[0,1,2,3] row_mask:0x8 bank_mask:0xf
    v_mov_b32_dpp v89, v101 quad_perm:[0,1,2,3] row_mask:0x8 bank_mask:0xf
    v_mov_b32_dpp v90, v102 quad_perm:[0,1,2,3] row_mask:0x8 bank_mask:0xf
    v_mov_b32_dpp v91, v103 quad_perm:[0,1,2,3] row_mask:0x8 bank_mask:0xf
    s_nop 0
    v_permlane32_swap_b32 v88, v90
    v_permlane32_swap_b32 v89, v91
    v_pk_add_f32 v[88:89], v[88:89], v[90:91]
    s_nop 1
    v_permlane16_swap_b32 v88, v89
    v_add_f32 v88, v88, v89
    v_bfi_b32 v88, v10, s56, v88
    buffer_store_dword v88, v7, s[32:35], s61 offen sc1
    s_branch L_dp1_done
.p2align 12
L_pad28:
    s_setpc_b64 s[12:13]
L_dp1_f1:
    buffer_load_dwordx4 v[72:75], v8, s[32:35], s42 offen offset:0 sc1
    buffer_load_dwordx4 v[76:79], v8, s[32:35], s42 offen offset:1024 sc1
L_dp1_2:
    s_waitcnt vmcnt(4)
    v_mfma_f32_16x16x32_bf16 v[88:91], v[80:83], a[0:3], 0
    v_max3_u32 v4, v80, v81, v82
    v_max3_u32 v4, v4, v83, v84
    v_max3_u32 v4, v4, v85, v86
    v_mfma_f32_16x16x32_bf16 v[88:91], v[84:87], a[16:19], v[88:91]
    v_max_u32 v4, v4, v87
    v_cmp_lt_u32 vcc, s50, v4
    s_cbranch_vccnz L_dp1_f2
    v_mfma_f32_16x16x32_bf16 v[92:95], v[80:83], a[4:7], 0
    v_mfma_f32_16x16x32_bf16 v[92:95], v[84:87], a[20:23], v[92:95]
    s_nop 1
    v_mfma_f32_16x16x32_bf16 v[96:99], v[80:83], a[8:11], 0
    s_nop 1
    v_mfma_f32_16x16x32_bf16 v[96:99], v[84:87], a[24:27], v[96:99]
    s_nop 1
    v_mfma_f32_16x16x32_bf16 v[100:103], v[80:83], a[12:15], 0
    v_mov_b32_dpp v88, v92 quad_perm:[0,1,2,3] row_mask:0x2 bank_mask:0xf
    v_mov_b32_dpp v89, v93 quad_perm:[0,1,2,3] row_mask:0x2 bank_mask:0xf
    v_mov_b32_dpp v90, v94 quad_perm:[0,1,2,3] row_mask:0x2 bank_mask:0xf
    v_mfma_f32_16x16x32_bf16 v[100:103], v[84:87], a[28:31], v[100:103]
    v_mov_b32_dpp v91, v95 quad_perm:[0,1,2,3] row_mask:0x2 bank_mask:0xf
    s_nop 0
    v_mov_b32_dpp v88, v96 quad_perm:[0,1,2,3] row_mask:0x4 bank_mask:0xf
    v_mov_b32_dpp v89, v97 quad_perm:[0,1,2,3] row_mask:0x4 bank_mask:0xf
    v_mov_b32_dpp v90, v98 quad_perm:[0,1,2,3] row_mask:0x4 bank_mask:0xf
    v_mov_b32_dpp v91, v99 quad_perm:[0,1,2,3] row_mask:0x4 bank_mask:0xf
    s_nop 1
    v_mov_b32_dpp v88, v100 quad_perm:[0,1,2,3] row_mask:0x8 bank_mask:0xf
    v_mov_b32_dpp v89, v101 quad_perm:[0,1,2,3] row_mask:0x8 bank_mask:0xf
    v_mov_b32_dpp v90, v102 quad_perm:[0,1,2,3] row_mask:0x8 bank_mask:0xf
    v_mov_b32_dpp v91, v103 quad_perm:[0,1,2,3] row_mask:0x8 bank_mask:0xf
    s_nop 0
    v_permlane32_swap_b32 v88, v90
    v_permlane32_swap_b32 v89, v91
    v_pk_add_f32 v[88:89], v[88:89], v[90:91]
    s_nop 1
    v_permlane16_swap_b32 v88, v89
    v_add_f32 v88, v88, v89
    v_bfi_b32 v88, v10, s56, v88
    buffer_store_dword v88, v7, s[32:35], s61 offen sc1
L_dp1_done:
    s_xor_b32 s61, s61, 8192
    buffer_store_dword v88, v7, s[32:35], s61 offen sc1
    s_barrier
L_c_end:
    s_endpgm
L_slow:
    s_mov_b32 s40, 1
L_prep:
    s_bitcmp1_b32 s42, 30
    s_cbranch_scc1 L_flags
    s_bitset1_b32 s42, 30
    v_and_b32 v88, 0x1f0, v8
    v_lshrrev_b32 v89, 5, v1
    v_lshl_add_u32 v88, v89, 12, v88
    s_lshl_b32 s3, s52, 5
    s_add_u32 s3, s3, s53
    s_lshl_b32 s3, s3, 9
    s_add_u32 s55, s3, s51
    s_add_u32 s55, s55, 114688
    s_add_u32 s41, s55, 8192
L_wt_ld:
    buffer_load_dwordx4 v[92:95], v88, s[32:35], s55 offen sc1
    buffer_load_dwordx4 v[96:99], v88, s[32:35], s41 offen sc1
    s_sub_i32 s49, s49, 1
    s_cmp_gt_i32 s49, 0
    s_cselect_b32 s58, 0, -1
    s_waitcnt vmcnt(0)
    v_bitop3_b32 v89, v92, v96, s57 bitop3:0x7e
    v_and_b32 v89, 0xff, v89
    v_cmp_lt_u32 vcc, s58, v89
    s_cbranch_vccnz L_wt_ld
    s_lshl_b32 s55, s45, 16
    s_add_u32 s55, s55, s3
    s_add_u32 s55, s55, 0x400000
    s_add_u32 s41, s55, 8192
    buffer_store_dwordx4 v[92:95], v88, s[32:35], s55 offen sc1
    buffer_store_dwordx4 v[96:99], v88, s[32:35], s41 offen sc1
    s_nop 1
    v_mov_b32 v88, -1
    v_mov_b32 v89, -1
    v_mov_b32 v90, -1
    v_mov_b32 v91, -1
    s_mul_i32 s41, s46, 3584
    s_add_u32 s41, s41, s51
    s_add_u32 s41, s41, 0x200000
    buffer_store_dwordx4 v[88:91], v8, s[32:35], s41 offen offset:0 sc1
    buffer_store_dwordx4 v[88:91], v8, s[32:35], s41 offen offset:1024 sc1
    buffer_store_dwordx4 v[88:91], v8, s[32:35], s41 offen offset:2048 sc1
    buffer_store_dwordx4 v[88:91], v8, s[32:35], s41 offen offset:2560 sc1
    s_sub_u32 s3, s56, 1
    v_mov_b32 v100, s3
    v_mov_b32 v101, s3
    v_mov_b32 v102, s3
    v_mov_b32 v103, s3
    s_lshl_b32 s41, s46, 11
    s_add_u32 s41, s41, s51
    s_add_u32 s41, s41, 0x21c000
    buffer_store_dwordx4 v[100:103], v8, s[32:35], s41 offen sc1
    buffer_store_dwordx4 v[100:103], v8, s[32:35], s41 offen offset:1024 sc1
    s_waitcnt vmcnt(0)
    s_lshl2_add_u32 s41, s46, s59
    v_mov_b32 v92, s56
    buffer_store_dword v92, v9, s[32:35], s41 offen sc1
L_flags:
    v_and_b32 v93, 124, v7
    buffer_load_dword v94, v93, s[32:35], s59 offen sc1
    s_sub_i32 s49, s49, 1
    s_waitcnt vmcnt(0)
    v_cmp_ne_u32 vcc, s56, v94
    s_cmp_lg_u32 s40, 0
    s_cbranch_scc1 L_flags2
    s_cbranch_vccnz L_q0_ld
    s_mov_b32 s54, s61
    s_branch L_q0_ld
L_flags2:
    s_cbranch_vccz L_slow_ret
    s_cmp_gt_i32 s49, 0
    s_cbranch_scc1 L_flags
    s_branch L_slow_ret
L_stub0:
    buffer_store_dword v112, v23, s[32:35], s54 offen sc1
    buffer_store_dwordx2 v[120:121], v9, s[32:35], s55 offen sc1
    s_branch L_stub0_r
L_stub1:
    buffer_store_dwordx4 v[80:83], v18, s[32:35], s41 offen sc1
    buffer_store_dwordx4 v[84:87], v18, s[32:35], s41 offen offset:512 sc1
    s_branch L_stub1_r
L_stub2:
    buffer_store_dwordx4 v[72:75], v18, s[32:35], s41 offen sc1
    buffer_store_dwordx4 v[76:79], v18, s[32:35], s41 offen offset:32 sc1
    buffer_store_dwordx4 v[80:83], v18, s[32:35], s42 offen sc1
    buffer_store_dwordx4 v[84:87], v18, s[32:35], s42 offen offset:32 sc1
    s_branch L_stub2_r
L_stub3:
    buffer_store_dwordx4 v[72:75], v17, s[32:35], s55 offen sc1
    buffer_store_dwordx4 v[76:79], v17, s[32:35], s41 offen sc1
    s_branch L_stub3_r
L_stub4:
    buffer_store_dwordx4 v[72:75], v16, s[32:35], s55 offen sc1
    s_branch L_stub4_r
L_stub5:
    buffer_store_dword v112, v23, s[32:35], s54 offen sc1
    s_branch L_stub5_r
L_stub6:
    buffer_store_dwordx4 v[72:75], v17, s[32:35], s55 offen sc1
    s_branch L_stub6_r
L_stub7:
    buffer_store_dword v5, v9, s[32:35], s41 offen sc1
    s_branch L_stub7_r
L_stub8:
    buffer_store_dword v116, v18, s[32:35], s3 offen offset:256 sc1
    buffer_store_dword v116, v18, s[32:35], s3 offen sc1
    s_branch L_stub8_r
L_stub9:
    buffer_store_short v88, v15, s[32:35], s41 offen sc1
    s_branch L_stub9_r
L_stub10:
    buffer_store_dword v116, v18, s[32:35], s3 offen sc1
    s_branch L_stub10_r
L_stub11:
    buffer_store_short v88, v14, s[32:35], s41 offen sc1
    s_branch L_stub11_r
L_stub12:
    buffer_store_dwordx2 v[96:97], v5, s[32:35], s42 offen sc1
    s_branch L_stub12_r
L_stub13:
    buffer_store_dword v116, v18, s[32:35], s3 offen sc1
    s_branch L_stub13_r
L_stub14:
    buffer_store_short v88, v15, s[32:35], s41 offen sc1
    s_branch L_stub14_r
L_end:
    s_endpgm
.section .rodata,"a"
.p2align 6
.amdhsa_kernel interleave_layers__sliding_block_cached__glu_gated_swiglu__decode_kernel
  .amdhsa_next_free_vgpr 256
  .amdhsa_next_free_sgpr 102
  .amdhsa_accum_offset 128
  .amdhsa_group_segment_fixed_size 0
  .amdhsa_kernarg_size 96
  .amdhsa_user_sgpr_count 2
  .amdhsa_user_sgpr_kernarg_segment_ptr 1
  .amdhsa_system_sgpr_workgroup_id_x 1
.end_amdhsa_kernel
```
